```python
import torch

def _softmax(x, axis=-1):
    return torch.softmax(x, dim=axis)

def _gelu(x):
    return torch.nn.functional.gelu(x, approximate='tanh')

def _silu(x):
    return torch.nn.functional.silu(x)

def _sigmoid(x):
    return torch.sigmoid(x)

def _layernorm(x, axis=-1, eps=1e-05):
    m = x.mean(dim=axis, keepdim=True)
    v = x.var(dim=axis, keepdim=True, unbiased=False)
    return (x - m) / torch.sqrt(v + eps)

def _scatter_add(tgt, idx, src, axis=0):
    return tgt.clone().index_add_(axis, idx, src)

def _segment_sum(src, seg, n):
    out = torch.zeros((n,) + src.shape[1:], dtype=src.dtype)
    return out.index_add_(0, seg, src)

def _pad(x, pw):
    flat = tuple((v for pair in reversed(pw) for v in pair))
    return torch.nn.functional.pad(x, flat)
kernel_name = 'standalone__kv_cache_quant_pre_rope_vs_post_rope__prompt'

def setup_inputs():

    _w = lambda a: (lambda t: t.to(torch.bfloat16) if t.is_floating_point() else t)(torch.as_tensor(a))
    B, Sq, Skv = (1, 2048, 2048)
    H, Dh0 = (8, 256)
    G = 64 if 64 > 0 else Dh0
    G = max(2, G // 2 * 2)
    Dh = max(G, Dh0 // G * G)
    Skv = max(Skv, Sq)
    ng = Dh // G
    bits = 8 if 8 > 1 else 4
    bits = max(2, min(8, bits))
    qmax = (1 << bits) - 1
    half = Dh // 2
    inv = 1.0 / 10000.0 ** (torch.arange(half) / max(1, half))
    ang_k = torch.arange(Skv)[:, None] * inv[None, :]
    ang_q = torch.arange(Skv - Sq, Skv)[:, None] * inv[None, :]
    kc = torch.cat([torch.cos(ang_k), torch.cos(ang_k)], dim=-1)
    ks = torch.cat([torch.sin(ang_k), torch.sin(ang_k)], dim=-1)
    qc = torch.cat([torch.cos(ang_q), torch.cos(ang_q)], dim=-1)
    qs = torch.cat([torch.sin(ang_q), torch.sin(ang_q)], dim=-1)
    qk_i = torch.randint(0, qmax + 1, (B, H, Skv, Dh)).to(torch.int32)
    qv_i = torch.randint(0, qmax + 1, (B, H, Skv, Dh)).to(torch.int32)
    ksc = torch.abs((lambda *s: torch.randn(*s, dtype=torch.bfloat16) * 0.05)(B, H, Skv, ng)) * 0.1 + 0.01
    kzp = torch.full((B, H, Skv, ng), qmax / 2.0)
    vsc = torch.abs((lambda *s: torch.randn(*s, dtype=torch.bfloat16) * 0.05)(B, H, Skv, ng)) * 0.1 + 0.01
    vzp = torch.full((B, H, Skv, ng), qmax / 2.0)
    return {'q': _w((lambda *s: torch.randn(*s, dtype=torch.bfloat16) * 0.8)(B, H, Sq, Dh) * 0.5), 'qk': _w(qk_i), 'k_scales': _w(ksc), 'k_zeros': _w(kzp), 'qv': _w(qv_i), 'v_scales': _w(vsc), 'v_zeros': _w(vzp), 'q_cos': _w(qc), 'q_sin': _w(qs), 'k_cos': _w(kc), 'k_sin': _w(ks)}

def reference(q, qk, k_scales, k_zeros, qv, v_scales, v_zeros, q_cos, q_sin, k_cos, k_sin):
    B, H, Sq, Dh = q.shape
    ng = k_scales.shape[-1]
    G = Dh // ng
    half = Dh // 2
    ks = (lambda x, n, axis: torch.repeat_interleave(x, n, dim=axis))(k_scales, G, axis=-1)
    kz = (lambda x, n, axis: torch.repeat_interleave(x, n, dim=axis))(k_zeros, G, axis=-1)
    k = ((lambda x, dt: x.to(dt))(qk, q.dtype) - kz) * ks
    vs = (lambda x, n, axis: torch.repeat_interleave(x, n, dim=axis))(v_scales, G, axis=-1)
    vz = (lambda x, n, axis: torch.repeat_interleave(x, n, dim=axis))(v_zeros, G, axis=-1)
    v = ((lambda x, dt: x.to(dt))(qv, q.dtype) - vz) * vs
    k1 = k[..., :half].clone()
    k2 = k[..., half:].clone()
    krh = torch.concatenate([-k2, k1], axis=-1)
    kr = k * k_cos[None, None, :, :] + krh * k_sin[None, None, :, :]
    q1 = q[..., :half].clone()
    q2 = q[..., half:].clone()
    qrh = torch.concatenate([-q2, q1], axis=-1)
    qr = q * q_cos[None, None, :, :] + qrh * q_sin[None, None, :, :]
    logits = torch.einsum('bhqd,bhkd->bhqk', qr, kr) * float(Dh) ** (-0.5)
    attn = _softmax(logits, axis=-1)
    out = torch.einsum('bhqk,bhkd->bhqd', attn, v)
    return out
```

```asm
; @launch grid=(256,1,1) block=(256,1,1) lds=66816
.amdgcn_target "amdgcn-amd-amdhsa--gfx950"
.text
.globl standalone__kv_cache_quant_pre_rope_vs_post_rope__prompt_kernel
.p2align 8
.type standalone__kv_cache_quant_pre_rope_vs_post_rope__prompt_kernel,@function
standalone__kv_cache_quant_pre_rope_vs_post_rope__prompt_kernel:
    s_cmp_ge_u32 s2, 256
    s_cbranch_scc1 L_done
    s_load_dwordx16 s[32:47], s[0:1], 0
    s_load_dwordx8 s[48:55], s[0:1], 64
    s_load_dwordx4 s[76:79], s[0:1], 96
    v_lshrrev_b32 v1, 6, v0
    v_and_b32 v0, 63, v0
    v_readfirstlane_b32 s100, v1
    s_and_b32 s101, s2, 7
    s_lshr_b32 s98, s2, 3
    s_getpc_b64 s[80:81]
L_pf_a:
    s_lshl_b32 s82, s98, 2
    s_add_u32 s82, s82, s100
    s_min_u32 s82, s82, 11
    s_add_u32 s82, s82, 0
    s_lshl_b32 s82, s82, 10
    s_sub_u32 s82, s82, L_pf_a - standalone__kv_cache_quant_pre_rope_vs_post_rope__prompt_kernel
    s_ashr_i32 s83, s82, 31
    s_add_u32 s80, s80, s82
    s_addc_u32 s81, s81, s83
    v_lshlrev_b32 v202, 4, v0
    v_mov_b32 v203, s81
    v_add_co_u32 v202, vcc, s80, v202
    s_nop 1
    v_addc_co_u32 v203, vcc, 0, v203, vcc
    global_load_dwordx4 a[252:255], v[202:203], off
    v_lshrrev_b32 v3, 2, v0
    v_and_b32 v2, 3, v0
    v_lshlrev_b32 v240, 10, v3
    v_lshl_add_u32 v240, v2, 5, v240
    v_lshlrev_b32 v241, 9, v3
    v_lshl_add_u32 v241, v2, 4, v241
    v_lshlrev_b32 v242, 3, v3
    s_lshl_b32 s4, s101, 3
    s_lshr_b32 s5, s98, 2
    s_add_u32 s4, s4, s5
    s_lshl_b32 s93, s4, 13
    s_lshl_b32 s5, s100, 6
    s_add_u32 s93, s93, s5
    s_and_b32 s6, s98, 3
    s_lshl_b32 s5, s6, 8
    s_add_u32 s5, s5, s4
    s_lshl_b32 s92, s5, 7
    s_lshl_b32 s91, s5, 14
    s_lshl_b32 s7, s100, 7
    s_add_u32 s91, s91, s7
    s_lshl_b32 s94, s6, 22
    s_lshr_b32 s5, s4, 1
    s_lshl_b32 s5, s5, 15
    s_add_u32 s94, s94, s5
    s_and_b32 s5, s4, 1
    s_lshl_b32 s5, s5, 13
    s_add_u32 s94, s94, s5
    s_lshl_b32 s5, s100, 10
    s_add_u32 s94, s94, s5
    s_waitcnt lgkmcnt(0)
    s_mov_b32 s20, s50
    s_and_b32 s21, s51, 0xffff
    s_mov_b32 s22, 0x100000
    s_mov_b32 s23, 0x20000
    s_mov_b32 s24, s52
    s_and_b32 s25, s53, 0xffff
    s_mov_b32 s26, 0x100000
    s_mov_b32 s27, 0x20000
    buffer_load_dwordx4 v[140:143], v241, s[20:23], s93 offen offset:0
    buffer_load_dwordx4 v[144:147], v241, s[24:27], s93 offen offset:0
    buffer_load_dwordx4 v[148:151], v241, s[20:23], s93 offen offset:256
    buffer_load_dwordx4 v[152:155], v241, s[24:27], s93 offen offset:256
    s_add_u32 s93, s93, 0x80000
    s_mov_b32 s8, s34
    s_and_b32 s9, s35, 0xffff
    s_mov_b32 s10, 0x1000000
    s_mov_b32 s11, 0x20000
    s_mov_b32 s12, s36
    s_and_b32 s13, s37, 0xffff
    s_mov_b32 s14, 0x20000
    s_mov_b32 s15, 0x20000
    s_mov_b32 s16, s38
    s_and_b32 s17, s39, 0xffff
    s_mov_b32 s18, 0x20000
    s_mov_b32 s19, 0x20000
    buffer_load_dwordx2 v[188:189], v242, s[12:15], s92 offen
    buffer_load_dwordx2 v[190:191], v242, s[16:19], s92 offen
    buffer_load_dwordx4 v[108:111], v240, s[8:11], s91 offen offset:0
    buffer_load_dwordx4 v[112:115], v240, s[8:11], s91 offen offset:16
    buffer_load_dwordx4 v[116:119], v240, s[8:11], s91 offen offset:512
    buffer_load_dwordx4 v[120:123], v240, s[8:11], s91 offen offset:528
    s_add_u32 s91, s91, 0x200000
    s_add_u32 s92, s92, 0x4000
    v_lshlrev_b32 v249, 12, v0
    v_add_u32 v249, 128, v249
    v_mov_b32 v253, 0x10000
    v_mov_b32 v4, 0
    ds_write_b32 v253, v4
    s_lshl_b32 s4, s100, 8
    s_add_u32 s4, s4, 0x10100
    v_lshl_add_u32 v5, v0, 2, s4
    ds_write_b32 v5, v4
    s_mov_b32 s6, s54
    s_mov_b32 s7, s55
    s_mov_b32 s52, s76
    s_and_b32 s53, s77, 0xffff
    s_mov_b32 s54, 0x100
    s_mov_b32 s55, 0x20000
    s_lshl_b32 s4, s2, 2
    s_add_u32 s4, s4, s100
    s_cmp_eq_u32 s4, 3
    s_cbranch_scc0 L_no_tag
    s_memrealtime s[80:81]
    s_waitcnt lgkmcnt(0)
    s_or_b32 s80, s80, 1
    s_or_b32 s81, s81, 0x80000000
    v_mov_b32 v232, s80
    v_mov_b32 v233, s81
    buffer_store_dwordx2 v[232:233], v249, s[52:55], 0 offen sc1
L_no_tag:
    s_waitcnt lgkmcnt(0)
    s_barrier
    s_mov_b32 s56, s40
    s_and_b32 s57, s41, 0xffff
    s_mov_b32 s58, 0x1000000
    s_mov_b32 s59, 0x20000
    s_mov_b32 s60, s42
    s_and_b32 s61, s43, 0xffff
    s_mov_b32 s62, 0x20000
    s_mov_b32 s63, 0x20000
    s_mov_b32 s64, s44
    s_and_b32 s65, s45, 0xffff
    s_mov_b32 s66, 0x20000
    s_mov_b32 s67, 0x20000
    s_mov_b32 s4, s32
    s_mov_b32 s5, s33
    s_mov_b32 s48, s48
    s_and_b32 s49, s49, 0xffff
    s_mov_b32 s50, 0x100000
    s_mov_b32 s51, 0x20000
    s_mov_b32 s44, s46
    s_and_b32 s45, s47, 0xffff
    s_mov_b32 s46, 0x100000
    s_mov_b32 s47, 0x20000
    s_mov_b32 s40, s4
    s_and_b32 s41, s5, 0xffff
    s_mov_b32 s42, 0x800000
    s_mov_b32 s43, 0x20000
    s_mov_b32 s36, s6
    s_and_b32 s37, s7, 0xffff
    s_mov_b32 s38, 0x800000
    s_mov_b32 s39, 0x20000
    s_mov_b32 s28, s78
    s_and_b32 s29, s79, 0xffff
    s_mov_b32 s30, 0x1000000
    s_mov_b32 s31, 0x20000
    s_add_u32 s4, s78, 0x1000000
    s_addc_u32 s5, s79, 0
    s_mov_b32 s32, s4
    s_and_b32 s33, s5, 0xffff
    s_mov_b32 s34, 0x1000
    s_mov_b32 s35, 0x20000
    s_lshl_b32 s4, s101, 21
    s_add_u32 s78, s78, s4
    s_addc_u32 s79, s79, 0
    s_mov_b32 s4, s78
    s_and_b32 s5, s79, 0xffff
    s_mov_b32 s6, 0x200000
    s_mov_b32 s7, 0x20000
    s_mov_b32 s72, 0xffff0000
    s_mov_b32 s74, 0x3db8aa3b
    s_and_b32 s73, s100, 2
    s_mul_i32 s73, s73, 0x01010000
    s_add_u32 s73, s73, 0x01000c0c
    s_and_b32 s88, s100, 1
    s_mul_i32 s88, s88, 0x02020000
    s_add_u32 s88, s88, 0x01000c0c
    v_lshlrev_b32 v243, 8, v2
    v_lshl_add_u32 v243, v3, 4, v243
    v_add_u32 v248, 0x1000, v243
    s_lshl_b32 s76, s100, 13
    v_add_u32 v247, s76, v243
    s_lshl_b32 s75, s98, 2
    s_add_u32 s75, s75, s100
    s_lshl_b32 s76, s75, 13
    v_add_u32 v246, s76, v241
    s_lshl_b32 s75, s101, 6
    s_add_u32 s75, s75, s98
    s_lshl_b32 s97, s75, 8
    s_lshr_b32 s76, s100, 1
    s_lshl_b32 s76, s76, 2
    s_add_u32 s97, s97, s76
    s_lshl_b32 s95, s75, 15
    s_lshl_b32 s76, s100, 8
    s_add_u32 s95, s95, s76
    s_add_u32 s96, s95, 0x4000
    s_lshr_b32 s76, s75, 2
    s_lshl_b32 s68, s76, 17
    s_and_b32 s76, s75, 3
    s_lshl_b32 s76, s76, 10
    s_add_u32 s68, s68, s76
    s_add_u32 s68, s68, 0x4000
    s_lshl_b32 s71, s101, 20
    v_lshrrev_b32 v4, 4, v0
    v_and_b32 v5, 15, v0
    v_lshlrev_b32 v244, 12, v4
    v_lshl_add_u32 v244, v5, 4, v244
    v_lshl_add_u32 v5, v4, 2, v2
    v_and_b32 v4, 4, v0
    v_lshl_add_u32 v5, v4, 2, v5
    v_lshlrev_b32 v245, 3, v5
    v_lshlrev_b32 v1, 4, v0
    s_lshl_b32 s76, s100, 15
    v_add_u32 v4, s76, v1
    v_add_u32 v5, 0x1000, v4
    v_add_u32 v6, 0x2000, v4
    v_add_u32 v7, 0x3000, v4
    s_lshl_b32 s76, s100, 12
    v_add_u32 v2, s76, v1
    v_lshlrev_b32 v3, 12, v0
    s_lshl_b32 s76, s2, 3
    v_add_u32 v3, s76, v3
    s_and_b32 s75, s98, 7
    s_mov_b32 s84, 0x76543210
    s_mov_b32 s85, 0xfedcba98
    s_cmp_eq_u32 s75, 1
    s_cselect_b32 s84, 0x32107654, s84
    s_cselect_b32 s85, 0x8fedcba9, s85
    s_cmp_eq_u32 s75, 2
    s_cselect_b32 s84, 0x76543210, s84
    s_cselect_b32 s85, 0x98fedcba, s85
    s_cmp_eq_u32 s75, 3
    s_cselect_b32 s84, 0x32107654, s84
    s_cselect_b32 s85, 0xa98fedcb, s85
    s_cmp_eq_u32 s75, 4
    s_cselect_b32 s84, 0x76543210, s84
    s_cselect_b32 s85, 0xba98fedc, s85
    s_cmp_eq_u32 s75, 5
    s_cselect_b32 s84, 0x32107654, s84
    s_cselect_b32 s85, 0xcba98fed, s85
    s_cmp_eq_u32 s75, 6
    s_cselect_b32 s84, 0x76543210, s84
    s_cselect_b32 s85, 0xdcba98fe, s85
    s_cmp_eq_u32 s75, 7
    s_cselect_b32 s84, 0x32107654, s84
    s_cselect_b32 s85, 0xedcba98f, s85
    v_lshrrev_b32 v251, 9, v246
    v_cvt_f32_u32 v251, v251
    s_mov_b32 s90, 0x31dc9c88
    s_and_b32 s75, s101, 4
    v_bfe_u32 v10, v246, 11, 3
    v_xor_b32 v10, s75, v10
    v_lshl_add_u32 v10, v10, 6, v246
    s_and_b32 s89, s101, 3
    s_lshl_b32 s89, s89, 2
    s_lshl_b32 s89, 0x000f000f, s89
    s_mov_b32 exec_lo, s89
    s_mov_b32 exec_hi, s89
    buffer_load_dword v8, v10, s[44:47], 0 offen
    buffer_load_dword v9, v10, s[48:51], 0 offen
    s_mov_b64 exec, -1
    buffer_load_dwordx2 v[192:193], v242, s[12:15], s92 offen
    buffer_load_dwordx2 v[194:195], v242, s[16:19], s92 offen
    buffer_load_dwordx4 v[124:127], v240, s[8:11], s91 offen offset:0
    buffer_load_dwordx4 v[128:131], v240, s[8:11], s91 offen offset:16
    buffer_load_dwordx4 v[132:135], v240, s[8:11], s91 offen offset:512
    buffer_load_dwordx4 v[136:139], v240, s[8:11], s91 offen offset:528
    s_sub_u32 s91, s91, 0x100000
    s_sub_u32 s92, s92, 0x2000
    v_mov_b32 v204, 0x3f800000
    v_mov_b32 v205, 0x3f6e39f8
    v_mov_b32 v206, 0x3f5dafd7
    v_mov_b32 v207, 0x3f4e4bad
    v_mov_b32 v208, 0x3f3ff911
    v_mov_b32 v209, 0x3f32a506
    v_mov_b32 v210, 0x3f263de0
    v_mov_b32 v211, 0x3f1ab32b
    s_mov_b32 exec_lo, 0x22222222
    s_mov_b32 exec_hi, 0x22222222
    v_mov_b32 v204, 0x3f0ff59a
    v_mov_b32 v205, 0x3f05f6ef
    v_mov_b32 v206, 0x3ef953cf
    v_mov_b32 v207, 0x3ee8045f
    v_mov_b32 v208, 0x3ed7e89b
    v_mov_b32 v209, 0x3ec8eb24
    v_mov_b32 v210, 0x3ebaf81b
    v_mov_b32 v211, 0x3eadfcff
    s_mov_b32 exec_lo, 0x44444444
    s_mov_b32 exec_hi, 0x44444444
    v_mov_b32 v204, 0x3ea1e89b
    v_mov_b32 v205, 0x3e96aaea
    v_mov_b32 v206, 0x3e8c3504
    v_mov_b32 v207, 0x3e827909
    v_mov_b32 v208, 0x3e72d423
    v_mov_b32 v209, 0x3e61f835
    v_mov_b32 v210, 0x3e5247ed
    v_mov_b32 v211, 0x3e43ae7c
    s_mov_b32 exec_lo, 0x88888888
    s_mov_b32 exec_hi, 0x88888888
    v_mov_b32 v204, 0x3e361887
    v_mov_b32 v205, 0x3e297409
    v_mov_b32 v206, 0x3e1db040
    v_mov_b32 v207, 0x3e12bd91
    v_mov_b32 v208, 0x3e088d77
    v_mov_b32 v209, 0x3dfe24e0
    v_mov_b32 v210, 0x3dec7fd6
    v_mov_b32 v211, 0x3ddc1466
    s_mov_b64 exec, -1
    v_mul_f32 v204, v251, v204
    v_mul_f32 v212, 0.15915494, v204
    v_floor_f32 v212, v212
    v_fma_f32 v212, v204, 0.15915494, -v212
    v_fma_f32 v212, v204, s90, v212
    v_mul_f32 v205, v251, v205
    v_mul_f32 v213, 0.15915494, v205
    v_floor_f32 v213, v213
    v_fma_f32 v213, v205, 0.15915494, -v213
    v_fma_f32 v213, v205, s90, v213
    v_mul_f32 v206, v251, v206
    v_mul_f32 v214, 0.15915494, v206
    v_floor_f32 v214, v214
    v_fma_f32 v214, v206, 0.15915494, -v214
    v_fma_f32 v214, v206, s90, v214
    v_mul_f32 v207, v251, v207
    v_mul_f32 v215, 0.15915494, v207
    v_floor_f32 v215, v215
    v_fma_f32 v215, v207, 0.15915494, -v215
    v_fma_f32 v215, v207, s90, v215
    v_mul_f32 v208, v251, v208
    v_mul_f32 v216, 0.15915494, v208
    v_floor_f32 v216, v216
    v_fma_f32 v216, v208, 0.15915494, -v216
    v_fma_f32 v216, v208, s90, v216
    v_mul_f32 v209, v251, v209
    v_mul_f32 v217, 0.15915494, v209
    v_floor_f32 v217, v217
    v_fma_f32 v217, v209, 0.15915494, -v217
    v_fma_f32 v217, v209, s90, v217
    v_mul_f32 v210, v251, v210
    v_mul_f32 v218, 0.15915494, v210
    v_floor_f32 v218, v218
    v_fma_f32 v218, v210, 0.15915494, -v218
    v_fma_f32 v218, v210, s90, v218
    v_mul_f32 v211, v251, v211
    v_mul_f32 v219, 0.15915494, v211
    v_floor_f32 v219, v219
    v_fma_f32 v219, v211, 0.15915494, -v219
    v_fma_f32 v219, v211, s90, v219
    v_cos_f32 v204, v212
    v_sin_f32 v212, v212
    v_cos_f32 v205, v213
    v_sin_f32 v213, v213
    v_cos_f32 v206, v214
    v_sin_f32 v214, v214
    v_cos_f32 v207, v215
    v_sin_f32 v215, v215
    v_cos_f32 v208, v216
    v_sin_f32 v216, v216
    v_cos_f32 v209, v217
    v_sin_f32 v217, v217
    v_cos_f32 v210, v218
    v_sin_f32 v218, v218
    v_cos_f32 v211, v219
    v_sin_f32 v219, v219
    v_cvt_pk_bf16_f32 v212, v204, v212
    v_cvt_pk_bf16_f32 v213, v205, v213
    v_cvt_pk_bf16_f32 v214, v206, v214
    v_cvt_pk_bf16_f32 v215, v207, v215
    v_cvt_pk_bf16_f32 v216, v208, v216
    v_cvt_pk_bf16_f32 v217, v209, v217
    v_cvt_pk_bf16_f32 v218, v210, v218
    v_cvt_pk_bf16_f32 v219, v211, v219
    v_accvgpr_write_b32 a192, v212
    v_accvgpr_write_b32 a193, v213
    v_accvgpr_write_b32 a194, v214
    v_accvgpr_write_b32 a195, v215
    v_accvgpr_write_b32 a196, v216
    v_accvgpr_write_b32 a197, v217
    v_accvgpr_write_b32 a198, v218
    v_accvgpr_write_b32 a199, v219
    v_mov_b32 v204, 0x3dcccccd
    v_mov_b32 v205, 0x3dbe94c6
    v_mov_b32 v206, 0x3db15978
    v_mov_b32 v207, 0x3da50956
    v_mov_b32 v208, 0x3d99940d
    v_mov_b32 v209, 0x3d8eea6b
    v_mov_b32 v210, 0x3d84fe4d
    v_mov_b32 v211, 0x3d778513
    s_mov_b32 exec_lo, 0x22222222
    s_mov_b32 exec_hi, 0x22222222
    v_mov_b32 v204, 0x3d6655c2
    v_mov_b32 v205, 0x3d5657e4
    v_mov_b32 v206, 0x3d47763f
    v_mov_b32 v207, 0x3d399d19
    v_mov_b32 v208, 0x3d2cba15
    v_mov_b32 v209, 0x3d20bc1d
    v_mov_b32 v210, 0x3d159348
    v_mov_b32 v211, 0x3d0b30cc
    s_mov_b32 exec_lo, 0x44444444
    s_mov_b32 exec_hi, 0x44444444
    v_mov_b32 v204, 0x3d0186e3
    v_mov_b32 v205, 0x3cf11177
    v_mov_b32 v206, 0x3ce054d2
    v_mov_b32 v207, 0x3cd0c1a8
    v_mov_b32 v208, 0x3cc2434f
    v_mov_b32 v209, 0x3cb4c691
    v_mov_b32 v210, 0x3ca8398b
    v_mov_b32 v211, 0x3c9c8b97
    s_mov_b32 exec_lo, 0x88888888
    s_mov_b32 exec_hi, 0x88888888
    v_mov_b32 v204, 0x3c91ad39
    v_mov_b32 v205, 0x3c879008
    v_mov_b32 v206, 0x3c7c4d33
    v_mov_b32 v207, 0x3c6ac8e7
    v_mov_b32 v208, 0x3c5a7bf2
    v_mov_b32 v209, 0x3c4b50b3
    v_mov_b32 v210, 0x3c3d3311
    v_mov_b32 v211, 0x3c301052
    s_mov_b64 exec, -1
    v_mul_f32 v204, v251, v204
    v_mul_f32 v212, 0.15915494, v204
    v_floor_f32 v212, v212
    v_fma_f32 v212, v204, 0.15915494, -v212
    v_fma_f32 v212, v204, s90, v212
    v_mul_f32 v205, v251, v205
    v_mul_f32 v213, 0.15915494, v205
    v_floor_f32 v213, v213
    v_fma_f32 v213, v205, 0.15915494, -v213
    v_fma_f32 v213, v205, s90, v213
    v_mul_f32 v206, v251, v206
    v_mul_f32 v214, 0.15915494, v206
    v_floor_f32 v214, v214
    v_fma_f32 v214, v206, 0.15915494, -v214
    v_fma_f32 v214, v206, s90, v214
    v_mul_f32 v207, v251, v207
    v_mul_f32 v215, 0.15915494, v207
    v_floor_f32 v215, v215
    v_fma_f32 v215, v207, 0.15915494, -v215
    v_fma_f32 v215, v207, s90, v215
    v_mul_f32 v208, v251, v208
    v_mul_f32 v216, 0.15915494, v208
    v_floor_f32 v216, v216
    v_fma_f32 v216, v208, 0.15915494, -v216
    v_fma_f32 v216, v208, s90, v216
    v_mul_f32 v209, v251, v209
    v_mul_f32 v217, 0.15915494, v209
    v_floor_f32 v217, v217
    v_fma_f32 v217, v209, 0.15915494, -v217
    v_fma_f32 v217, v209, s90, v217
    v_mul_f32 v210, v251, v210
    v_mul_f32 v218, 0.15915494, v210
    v_floor_f32 v218, v218
    v_fma_f32 v218, v210, 0.15915494, -v218
    v_fma_f32 v218, v210, s90, v218
    v_mul_f32 v211, v251, v211
    v_mul_f32 v219, 0.15915494, v211
    v_floor_f32 v219, v219
    v_fma_f32 v219, v211, 0.15915494, -v219
    v_fma_f32 v219, v211, s90, v219
    v_cos_f32 v204, v212
    v_sin_f32 v212, v212
    v_cos_f32 v205, v213
    v_sin_f32 v213, v213
    v_cos_f32 v206, v214
    v_sin_f32 v214, v214
    v_cos_f32 v207, v215
    v_sin_f32 v215, v215
    v_cos_f32 v208, v216
    v_sin_f32 v216, v216
    v_cos_f32 v209, v217
    v_sin_f32 v217, v217
    v_cos_f32 v210, v218
    v_sin_f32 v218, v218
    v_cos_f32 v211, v219
    v_sin_f32 v219, v219
    v_cvt_pk_bf16_f32 v212, v204, v212
    v_cvt_pk_bf16_f32 v213, v205, v213
    v_cvt_pk_bf16_f32 v214, v206, v214
    v_cvt_pk_bf16_f32 v215, v207, v215
    v_cvt_pk_bf16_f32 v216, v208, v216
    v_cvt_pk_bf16_f32 v217, v209, v217
    v_cvt_pk_bf16_f32 v218, v210, v218
    v_cvt_pk_bf16_f32 v219, v211, v219
    v_accvgpr_write_b32 a200, v212
    v_accvgpr_write_b32 a201, v213
    v_accvgpr_write_b32 a202, v214
    v_accvgpr_write_b32 a203, v215
    v_accvgpr_write_b32 a204, v216
    v_accvgpr_write_b32 a205, v217
    v_accvgpr_write_b32 a206, v218
    v_accvgpr_write_b32 a207, v219
    s_waitcnt vmcnt(14)
    buffer_load_dword v220, v245, s[60:63], s97 offen
    buffer_load_dword v221, v245, s[64:67], s97 offen
    buffer_load_dwordx4 v[44:47], v244, s[56:59], s95 offen offset:0
    buffer_load_dwordx4 v[48:51], v244, s[56:59], s95 offen offset:1024
    buffer_load_dwordx4 v[52:55], v244, s[56:59], s95 offen offset:2048
    buffer_load_dwordx4 v[56:59], v244, s[56:59], s95 offen offset:3072
    v_mov_b32 v204, 0x3c23d70a
    v_mov_b32 v205, 0x3c187705
    v_mov_b32 v206, 0x3c0de12d
    v_mov_b32 v207, 0x3c040779
    v_mov_b32 v208, 0x3bf5b9b0
    v_mov_b32 v209, 0x3be4aa46
    v_mov_b32 v210, 0x3bd4ca15
    v_mov_b32 v211, 0x3bc6040f
    s_mov_b32 exec_lo, 0x22222222
    s_mov_b32 exec_hi, 0x22222222
    v_mov_b32 v204, 0x3bb8449c
    v_mov_b32 v205, 0x3bab7983
    v_mov_b32 v206, 0x3b9f91cc
    v_mov_b32 v207, 0x3b947dae
    v_mov_b32 v208, 0x3b8a2e77
    v_mov_b32 v209, 0x3b80967d
    v_mov_b32 v210, 0x3b6f520e
    v_mov_b32 v211, 0x3b5eb47a
    s_mov_b32 exec_lo, 0x44444444
    s_mov_b32 exec_hi, 0x44444444
    v_mov_b32 v204, 0x3b4f3e38
    v_mov_b32 v205, 0x3b40dac5
    v_mov_b32 v206, 0x3b33770f
    v_mov_b32 v207, 0x3b270153
    v_mov_b32 v208, 0x3b1b690d
    v_mov_b32 v209, 0x3b109edb
    v_mov_b32 v210, 0x3b06946f
    v_mov_b32 v211, 0x3afa78f0
    s_mov_b32 exec_lo, 0x88888888
    s_mov_b32 exec_hi, 0x88888888
    v_mov_b32 v204, 0x3ae91528
    v_mov_b32 v205, 0x3ad8e673
    v_mov_b32 v206, 0x3ac9d75c
    v_mov_b32 v207, 0x3abbd3ed
    v_mov_b32 v208, 0x3aaec98e
    v_mov_b32 v209, 0x3aa2a6f7
    v_mov_b32 v210, 0x3a975c0e
    v_mov_b32 v211, 0x3a8cd9db
    s_mov_b64 exec, -1
    v_mul_f32 v204, v251, v204
    v_mul_f32 v212, 0.15915494, v204
    v_floor_f32 v212, v212
    v_fma_f32 v212, v204, 0.15915494, -v212
    v_fma_f32 v212, v204, s90, v212
    v_mul_f32 v205, v251, v205
    v_mul_f32 v213, 0.15915494, v205
    v_floor_f32 v213, v213
    v_fma_f32 v213, v205, 0.15915494, -v213
    v_fma_f32 v213, v205, s90, v213
    v_mul_f32 v206, v251, v206
    v_mul_f32 v214, 0.15915494, v206
    v_floor_f32 v214, v214
    v_fma_f32 v214, v206, 0.15915494, -v214
    v_fma_f32 v214, v206, s90, v214
    v_mul_f32 v207, v251, v207
    v_mul_f32 v215, 0.15915494, v207
    v_floor_f32 v215, v215
    v_fma_f32 v215, v207, 0.15915494, -v215
    v_fma_f32 v215, v207, s90, v215
    v_mul_f32 v208, v251, v208
    v_mul_f32 v216, 0.15915494, v208
    v_floor_f32 v216, v216
    v_fma_f32 v216, v208, 0.15915494, -v216
    v_fma_f32 v216, v208, s90, v216
    v_mul_f32 v209, v251, v209
    v_mul_f32 v217, 0.15915494, v209
    v_floor_f32 v217, v217
    v_fma_f32 v217, v209, 0.15915494, -v217
    v_fma_f32 v217, v209, s90, v217
    v_mul_f32 v210, v251, v210
    v_mul_f32 v218, 0.15915494, v210
    v_floor_f32 v218, v218
    v_fma_f32 v218, v210, 0.15915494, -v218
    v_fma_f32 v218, v210, s90, v218
    v_mul_f32 v211, v251, v211
    v_mul_f32 v219, 0.15915494, v211
    v_floor_f32 v219, v219
    v_fma_f32 v219, v211, 0.15915494, -v219
    v_fma_f32 v219, v211, s90, v219
    v_cos_f32 v204, v212
    v_sin_f32 v212, v212
    v_cos_f32 v205, v213
    v_sin_f32 v213, v213
    v_cos_f32 v206, v214
    v_sin_f32 v214, v214
    v_cos_f32 v207, v215
    v_sin_f32 v215, v215
    v_cos_f32 v208, v216
    v_sin_f32 v216, v216
    v_cos_f32 v209, v217
    v_sin_f32 v217, v217
    v_cos_f32 v210, v218
    v_sin_f32 v218, v218
    v_cos_f32 v211, v219
    v_sin_f32 v219, v219
    v_cvt_pk_bf16_f32 v212, v204, v212
    v_cvt_pk_bf16_f32 v213, v205, v213
    v_cvt_pk_bf16_f32 v214, v206, v214
    v_cvt_pk_bf16_f32 v215, v207, v215
    v_cvt_pk_bf16_f32 v216, v208, v216
    v_cvt_pk_bf16_f32 v217, v209, v217
    v_cvt_pk_bf16_f32 v218, v210, v218
    v_cvt_pk_bf16_f32 v219, v211, v219
    v_accvgpr_write_b32 a208, v212
    v_accvgpr_write_b32 a209, v213
    v_accvgpr_write_b32 a210, v214
    v_accvgpr_write_b32 a211, v215
    v_accvgpr_write_b32 a212, v216
    v_accvgpr_write_b32 a213, v217
    v_accvgpr_write_b32 a214, v218
    v_accvgpr_write_b32 a215, v219
    buffer_load_dwordx2 v[234:235], v249, s[52:55], 0 offen sc1
    v_lshlrev_b32 v156, 16, v140
    v_and_b32 v157, s72, v140
    v_lshlrev_b32 v158, 16, v141
    v_and_b32 v159, s72, v141
    v_lshlrev_b32 v160, 16, v142
    v_and_b32 v161, s72, v142
    v_lshlrev_b32 v162, 16, v143
    v_and_b32 v163, s72, v143
    v_lshlrev_b32 v164, 16, v144
    v_and_b32 v165, s72, v144
    v_lshlrev_b32 v166, 16, v145
    v_and_b32 v167, s72, v145
    v_lshlrev_b32 v168, 16, v146
    v_and_b32 v169, s72, v146
    v_lshlrev_b32 v170, 16, v147
    v_and_b32 v171, s72, v147
    v_lshlrev_b32 v172, 16, v148
    v_and_b32 v173, s72, v148
    v_lshlrev_b32 v174, 16, v149
    v_and_b32 v175, s72, v149
    v_lshlrev_b32 v176, 16, v150
    v_and_b32 v177, s72, v150
    v_lshlrev_b32 v178, 16, v151
    v_and_b32 v179, s72, v151
    v_lshlrev_b32 v180, 16, v152
    v_and_b32 v181, s72, v152
    v_lshlrev_b32 v182, 16, v153
    v_and_b32 v183, s72, v153
    v_lshlrev_b32 v184, 16, v154
    v_and_b32 v185, s72, v154
    v_lshlrev_b32 v186, 16, v155
    v_and_b32 v187, s72, v155
    s_waitcnt vmcnt(15)
    v_perm_b32 v188, v188, v188, s73
    v_perm_b32 v189, v189, v189, s73
    v_perm_b32 v190, v190, v190, s73
    v_perm_b32 v191, v191, v191, s73
    v_mul_f32 v188, s74, v188
    v_mul_f32 v189, s74, v189
    v_mul_f32 v190, -v190, v188
    v_mul_f32 v191, -v191, v189
    v_cvt_f32_i32 v108, v108
    v_cvt_f32_i32 v116, v116
    v_fma_f32 v108, v108, v188, v190
    v_fma_f32 v116, v116, v189, v191
    v_mul_f32 v230, v156, v108
    v_mul_f32 v231, v180, v108
    v_fma_f32 v108, -v116, v164, v230
    v_fma_f32 v116, v116, v172, v231
    v_cvt_f32_i32 v109, v109
    v_cvt_f32_i32 v117, v117
    v_fma_f32 v109, v109, v188, v190
    v_fma_f32 v117, v117, v189, v191
    v_mul_f32 v230, v157, v109
    v_mul_f32 v231, v181, v109
    v_fma_f32 v109, -v117, v165, v230
    v_fma_f32 v117, v117, v173, v231
    v_cvt_pk_bf16_f32 v108, v108, v109
    v_cvt_pk_bf16_f32 v116, v116, v117
    v_cvt_f32_i32 v110, v110
    v_cvt_f32_i32 v118, v118
    v_fma_f32 v110, v110, v188, v190
    v_fma_f32 v118, v118, v189, v191
    v_mul_f32 v230, v158, v110
    v_mul_f32 v231, v182, v110
    v_fma_f32 v110, -v118, v166, v230
    v_fma_f32 v118, v118, v174, v231
    v_cvt_f32_i32 v111, v111
    v_cvt_f32_i32 v119, v119
    v_fma_f32 v111, v111, v188, v190
    v_fma_f32 v119, v119, v189, v191
    v_mul_f32 v230, v159, v111
    v_mul_f32 v231, v183, v111
    v_fma_f32 v111, -v119, v167, v230
    v_fma_f32 v119, v119, v175, v231
    v_cvt_pk_bf16_f32 v109, v110, v111
    v_cvt_pk_bf16_f32 v117, v118, v119
    v_cvt_f32_i32 v112, v112
    v_cvt_f32_i32 v120, v120
    v_fma_f32 v112, v112, v188, v190
    v_fma_f32 v120, v120, v189, v191
    v_mul_f32 v230, v160, v112
    v_mul_f32 v231, v184, v112
    v_fma_f32 v112, -v120, v168, v230
    v_fma_f32 v120, v120, v176, v231
    v_cvt_f32_i32 v113, v113
    v_cvt_f32_i32 v121, v121
    v_fma_f32 v113, v113, v188, v190
    v_fma_f32 v121, v121, v189, v191
    v_mul_f32 v230, v161, v113
    v_mul_f32 v231, v185, v113
    v_fma_f32 v113, -v121, v169, v230
    v_fma_f32 v121, v121, v177, v231
    v_cvt_pk_bf16_f32 v110, v112, v113
    v_cvt_pk_bf16_f32 v118, v120, v121
    v_cvt_f32_i32 v114, v114
    v_cvt_f32_i32 v122, v122
    v_fma_f32 v114, v114, v188, v190
    v_fma_f32 v122, v122, v189, v191
    v_mul_f32 v230, v162, v114
    v_mul_f32 v231, v186, v114
    v_fma_f32 v114, -v122, v170, v230
    v_fma_f32 v122, v122, v178, v231
    v_cvt_f32_i32 v115, v115
    v_cvt_f32_i32 v123, v123
    v_fma_f32 v115, v115, v188, v190
    v_fma_f32 v123, v123, v189, v191
    v_mul_f32 v230, v163, v115
    v_mul_f32 v231, v187, v115
    v_fma_f32 v115, -v123, v171, v230
    v_fma_f32 v123, v123, v179, v231
    v_cvt_pk_bf16_f32 v111, v114, v115
    v_cvt_pk_bf16_f32 v119, v122, v123
    buffer_store_dwordx4 v[108:111], v243, s[28:31], s94 offen sc1
    buffer_store_dwordx4 v[116:119], v248, s[28:31], s94 offen sc1
    s_add_u32 s94, s94, 0x200000
    buffer_load_dwordx4 v[60:63], v244, s[56:59], s96 offen offset:0
    buffer_load_dwordx4 v[64:67], v244, s[56:59], s96 offen offset:1024
    buffer_load_dwordx4 v[68:71], v244, s[56:59], s96 offen offset:2048
    buffer_load_dwordx4 v[72:75], v244, s[56:59], s96 offen offset:3072
    s_add_u32 s95, s95, 0x100000
    s_add_u32 s96, s96, 0x100000
    s_add_u32 s97, s97, 0x2000
    s_waitcnt vmcnt(13)
    v_perm_b32 v192, v192, v192, s73
    v_perm_b32 v193, v193, v193, s73
    v_perm_b32 v194, v194, v194, s73
    v_perm_b32 v195, v195, v195, s73
    v_mul_f32 v192, s74, v192
    v_mul_f32 v193, s74, v193
    v_mul_f32 v194, -v194, v192
    v_mul_f32 v195, -v195, v193
    v_cvt_f32_i32 v124, v124
    v_cvt_f32_i32 v132, v132
    v_fma_f32 v124, v124, v192, v194
    v_fma_f32 v132, v132, v193, v195
    v_mul_f32 v230, v156, v124
    v_mul_f32 v231, v180, v124
    v_fma_f32 v124, -v132, v164, v230
    v_fma_f32 v132, v132, v172, v231
    v_cvt_f32_i32 v125, v125
    v_cvt_f32_i32 v133, v133
    v_fma_f32 v125, v125, v192, v194
    v_fma_f32 v133, v133, v193, v195
    v_mul_f32 v230, v157, v125
    v_mul_f32 v231, v181, v125
    v_fma_f32 v125, -v133, v165, v230
    v_fma_f32 v133, v133, v173, v231
    v_cvt_pk_bf16_f32 v124, v124, v125
    v_cvt_pk_bf16_f32 v132, v132, v133
    v_cvt_f32_i32 v126, v126
    v_cvt_f32_i32 v134, v134
    v_fma_f32 v126, v126, v192, v194
    v_fma_f32 v134, v134, v193, v195
    v_mul_f32 v230, v158, v126
    v_mul_f32 v231, v182, v126
    v_fma_f32 v126, -v134, v166, v230
    v_fma_f32 v134, v134, v174, v231
    v_cvt_f32_i32 v127, v127
    v_cvt_f32_i32 v135, v135
    v_fma_f32 v127, v127, v192, v194
    v_fma_f32 v135, v135, v193, v195
    v_mul_f32 v230, v159, v127
    v_mul_f32 v231, v183, v127
    v_fma_f32 v127, -v135, v167, v230
    v_fma_f32 v135, v135, v175, v231
    v_cvt_pk_bf16_f32 v125, v126, v127
    v_cvt_pk_bf16_f32 v133, v134, v135
    v_cvt_f32_i32 v128, v128
    v_cvt_f32_i32 v136, v136
    v_fma_f32 v128, v128, v192, v194
    v_fma_f32 v136, v136, v193, v195
    v_mul_f32 v230, v160, v128
    v_mul_f32 v231, v184, v128
    v_fma_f32 v128, -v136, v168, v230
    v_fma_f32 v136, v136, v176, v231
    v_cvt_f32_i32 v129, v129
    v_cvt_f32_i32 v137, v137
    v_fma_f32 v129, v129, v192, v194
    v_fma_f32 v137, v137, v193, v195
    v_mul_f32 v230, v161, v129
    v_mul_f32 v231, v185, v129
    v_fma_f32 v129, -v137, v169, v230
    v_fma_f32 v137, v137, v177, v231
    v_cvt_pk_bf16_f32 v126, v128, v129
    v_cvt_pk_bf16_f32 v134, v136, v137
    v_cvt_f32_i32 v130, v130
    v_cvt_f32_i32 v138, v138
    v_fma_f32 v130, v130, v192, v194
    v_fma_f32 v138, v138, v193, v195
    v_mul_f32 v230, v162, v130
    v_mul_f32 v231, v186, v130
    v_fma_f32 v130, -v138, v170, v230
    v_fma_f32 v138, v138, v178, v231
    v_cvt_f32_i32 v131, v131
    v_cvt_f32_i32 v139, v139
    v_fma_f32 v131, v131, v192, v194
    v_fma_f32 v139, v139, v193, v195
    v_mul_f32 v230, v163, v131
    v_mul_f32 v231, v187, v131
    v_fma_f32 v131, -v139, v171, v230
    v_fma_f32 v139, v139, v179, v231
    v_cvt_pk_bf16_f32 v127, v130, v131
    v_cvt_pk_bf16_f32 v135, v138, v139
    buffer_store_dwordx4 v[124:127], v243, s[28:31], s94 offen sc1
    buffer_store_dwordx4 v[132:135], v248, s[28:31], s94 offen sc1
    s_sub_u32 s94, s94, 0x100000
    v_mov_b32 v204, 0x3a83126f
    v_mov_b32 v205, 0x3a73f1a3
    v_mov_b32 v206, 0x3a6301e2
    v_mov_b32 v207, 0x3a533f28
    v_mov_b32 v208, 0x3a44948c
    v_mov_b32 v209, 0x3a36ee9e
    v_mov_b32 v210, 0x3a2a3b44
    v_mov_b32 v211, 0x3a1e69a5
    s_mov_b32 exec_lo, 0x22222222
    s_mov_b32 exec_hi, 0x22222222
    v_mov_b32 v204, 0x3a136a16
    v_mov_b32 v205, 0x3a092e02
    v_mov_b32 v206, 0x39ff4fac
    v_mov_b32 v207, 0x39ed95e2
    v_mov_b32 v208, 0x39dd1725
    v_mov_b32 v209, 0x39cdbd96
    v_mov_b32 v210, 0x39bf74d7
    v_mov_b32 v211, 0x39b229fb
    s_mov_b32 exec_lo, 0x44444444
    s_mov_b32 exec_hi, 0x44444444
    v_mov_b32 v204, 0x39a5cb60
    v_mov_b32 v205, 0x399a489e
    v_mov_b32 v206, 0x398f9272
    v_mov_b32 v207, 0x39859aa9
    v_mov_b32 v208, 0x3978a815
    v_mov_b32 v209, 0x39676492
    v_mov_b32 v210, 0x395753e4
    v_mov_b32 v211, 0x394860c1
    s_mov_b32 exec_lo, 0x88888888
    s_mov_b32 exec_hi, 0x88888888
    v_mov_b32 v204, 0x393a7753
    v_mov_b32 v205, 0x392d8529
    v_mov_b32 v206, 0x39217916
    v_mov_b32 v207, 0x39164324
    v_mov_b32 v208, 0x390bd472
    v_mov_b32 v209, 0x39021f2b
    v_mov_b32 v210, 0x38f22ce2
    v_mov_b32 v211, 0x38e15c91
    s_mov_b64 exec, -1
    v_mul_f32 v204, v251, v204
    v_mul_f32 v212, 0.15915494, v204
    v_floor_f32 v212, v212
    v_fma_f32 v212, v204, 0.15915494, -v212
    v_fma_f32 v212, v204, s90, v212
    v_mul_f32 v205, v251, v205
    v_mul_f32 v213, 0.15915494, v205
    v_floor_f32 v213, v213
    v_fma_f32 v213, v205, 0.15915494, -v213
    v_fma_f32 v213, v205, s90, v213
    v_mul_f32 v206, v251, v206
    v_mul_f32 v214, 0.15915494, v206
    v_floor_f32 v214, v214
    v_fma_f32 v214, v206, 0.15915494, -v214
    v_fma_f32 v214, v206, s90, v214
    v_mul_f32 v207, v251, v207
    v_mul_f32 v215, 0.15915494, v207
    v_floor_f32 v215, v215
    v_fma_f32 v215, v207, 0.15915494, -v215
    v_fma_f32 v215, v207, s90, v215
    v_mul_f32 v208, v251, v208
    v_mul_f32 v216, 0.15915494, v208
    v_floor_f32 v216, v216
    v_fma_f32 v216, v208, 0.15915494, -v216
    v_fma_f32 v216, v208, s90, v216
    v_mul_f32 v209, v251, v209
    v_mul_f32 v217, 0.15915494, v209
    v_floor_f32 v217, v217
    v_fma_f32 v217, v209, 0.15915494, -v217
    v_fma_f32 v217, v209, s90, v217
    v_mul_f32 v210, v251, v210
    v_mul_f32 v218, 0.15915494, v210
    v_floor_f32 v218, v218
    v_fma_f32 v218, v210, 0.15915494, -v218
    v_fma_f32 v218, v210, s90, v218
    v_mul_f32 v211, v251, v211
    v_mul_f32 v219, 0.15915494, v211
    v_floor_f32 v219, v219
    v_fma_f32 v219, v211, 0.15915494, -v219
    v_fma_f32 v219, v211, s90, v219
    v_cos_f32 v204, v212
    v_sin_f32 v212, v212
    v_cos_f32 v205, v213
    v_sin_f32 v213, v213
    v_cos_f32 v206, v214
    v_sin_f32 v214, v214
    v_cos_f32 v207, v215
    v_sin_f32 v215, v215
    v_cos_f32 v208, v216
    v_sin_f32 v216, v216
    v_cos_f32 v209, v217
    v_sin_f32 v217, v217
    v_cos_f32 v210, v218
    v_sin_f32 v218, v218
    v_cos_f32 v211, v219
    v_sin_f32 v219, v219
    v_cvt_pk_bf16_f32 v212, v204, v212
    v_cvt_pk_bf16_f32 v213, v205, v213
    v_cvt_pk_bf16_f32 v214, v206, v214
    v_cvt_pk_bf16_f32 v215, v207, v215
    v_cvt_pk_bf16_f32 v216, v208, v216
    v_cvt_pk_bf16_f32 v217, v209, v217
    v_cvt_pk_bf16_f32 v218, v210, v218
    v_cvt_pk_bf16_f32 v219, v211, v219
    v_accvgpr_write_b32 a216, v212
    v_accvgpr_write_b32 a217, v213
    v_accvgpr_write_b32 a218, v214
    v_accvgpr_write_b32 a219, v215
    v_accvgpr_write_b32 a220, v216
    v_accvgpr_write_b32 a221, v217
    v_accvgpr_write_b32 a222, v218
    v_accvgpr_write_b32 a223, v219
    v_bfe_u32 v198, v246, 11, 2
    v_accvgpr_read_b32 v196, a192
    v_accvgpr_read_b32 v197, a193
    v_cmp_eq_u32 vcc, 1, v198
    v_accvgpr_read_b32 v199, a200
    v_accvgpr_read_b32 v200, a201
    v_cndmask_b32 v196, v196, v199, vcc
    v_cndmask_b32 v197, v197, v200, vcc
    v_cmp_eq_u32 vcc, 2, v198
    v_accvgpr_read_b32 v199, a208
    v_accvgpr_read_b32 v200, a209
    v_cndmask_b32 v196, v196, v199, vcc
    v_cndmask_b32 v197, v197, v200, vcc
    v_cmp_eq_u32 vcc, 3, v198
    v_accvgpr_read_b32 v199, a216
    v_accvgpr_read_b32 v200, a217
    v_cndmask_b32 v196, v196, v199, vcc
    v_cndmask_b32 v197, v197, v200, vcc
    s_mov_b32 s75, 0x3c028f5c
    v_mov_b32 v198, 0x38000000
    s_mov_b32 s76, 0
    s_mov_b32 s80, s89
    s_mov_b32 s81, s89
    s_mov_b32 s82, 0
    v_lshlrev_b32 v199, 16, v196
    v_lshlrev_b32 v200, 16, v8
    v_sub_f32 v200, v200, v199
    v_fma_f32 v199, abs(v199), s75, v198
    v_cmp_nge_f32 vcc, v199, abs(v200)
    v_cmp_neq_f32 s[78:79], 0, v200
    s_nop 3
    s_or_b32 s76, s76, vcc_lo
    s_or_b32 s76, s76, vcc_hi
    s_and_b64 vcc, s[78:79], s[80:81]
    s_bcnt1_i32_b64 s83, vcc
    s_add_u32 s82, s82, s83
    v_and_b32 v199, s72, v196
    v_lshlrev_b32 v200, 16, v9
    v_sub_f32 v200, v200, v199
    v_fma_f32 v199, abs(v199), s75, v198
    v_cmp_nge_f32 vcc, v199, abs(v200)
    v_cmp_neq_f32 s[78:79], 0, v200
    s_nop 3
    s_or_b32 s76, s76, vcc_lo
    s_or_b32 s76, s76, vcc_hi
    s_and_b64 vcc, s[78:79], s[80:81]
    s_bcnt1_i32_b64 s83, vcc
    s_add_u32 s82, s82, s83
    v_lshlrev_b32 v199, 16, v197
    v_and_b32 v200, s72, v8
    v_sub_f32 v200, v200, v199
    v_fma_f32 v199, abs(v199), s75, v198
    v_cmp_nge_f32 vcc, v199, abs(v200)
    v_cmp_neq_f32 s[78:79], 0, v200
    s_nop 3
    s_or_b32 s76, s76, vcc_lo
    s_or_b32 s76, s76, vcc_hi
    s_and_b64 vcc, s[78:79], s[80:81]
    s_bcnt1_i32_b64 s83, vcc
    s_add_u32 s82, s82, s83
    v_and_b32 v199, s72, v197
    v_and_b32 v200, s72, v9
    v_sub_f32 v200, v200, v199
    v_fma_f32 v199, abs(v199), s75, v198
    v_cmp_nge_f32 vcc, v199, abs(v200)
    v_cmp_neq_f32 s[78:79], 0, v200
    s_nop 3
    s_or_b32 s76, s76, vcc_lo
    s_or_b32 s76, s76, vcc_hi
    s_and_b64 vcc, s[78:79], s[80:81]
    s_bcnt1_i32_b64 s83, vcc
    s_add_u32 s82, s82, s83
    s_cmp_gt_u32 s82, 2
    s_cselect_b32 s76, -1, s76
    s_and_b32 s89, s89, s76
    s_cselect_b32 s89, 1, 0
    s_waitcnt vmcnt(9)
    buffer_load_dwordx4 v[12:15], v246, s[40:43], s71 offen offset:0
    buffer_load_dwordx4 v[28:31], v246, s[40:43], s71 offen offset:256
    buffer_load_dwordx4 v[16:19], v246, s[40:43], s71 offen offset:64
    buffer_load_dwordx4 v[32:35], v246, s[40:43], s71 offen offset:320
    v_perm_b32 v224, v220, v220, s88
    v_perm_b32 v225, v221, v221, s88
    v_mul_f32 v225, -v225, v224
    v_cvt_f32_i32 v44, v44
    v_cvt_f32_i32 v45, v45
    v_cvt_f32_i32 v46, v46
    v_cvt_f32_i32 v47, v47
    v_mov_b32_dpp v226, v224 row_newbcast:0 row_mask:0xf bank_mask:0xf
    v_mov_b32_dpp v227, v225 row_newbcast:0 row_mask:0xf bank_mask:0xf
    v_fma_f32 v44, v44, v226, v227
    v_fma_f32 v45, v45, v226, v227
    v_fma_f32 v46, v46, v226, v227
    v_fma_f32 v47, v47, v226, v227
    v_cvt_f32_i32 v48, v48
    v_cvt_f32_i32 v49, v49
    v_cvt_f32_i32 v50, v50
    v_cvt_f32_i32 v51, v51
    v_mov_b32_dpp v228, v224 row_newbcast:1 row_mask:0xf bank_mask:0xf
    v_mov_b32_dpp v229, v225 row_newbcast:1 row_mask:0xf bank_mask:0xf
    v_fma_f32 v48, v48, v228, v229
    v_fma_f32 v49, v49, v228, v229
    v_fma_f32 v50, v50, v228, v229
    v_fma_f32 v51, v51, v228, v229
    v_cvt_pk_bf16_f32 v204, v44, v48
    v_cvt_pk_bf16_f32 v208, v45, v49
    v_cvt_pk_bf16_f32 v44, v46, v50
    v_cvt_pk_bf16_f32 v48, v47, v51
    v_cvt_f32_i32 v52, v52
    v_cvt_f32_i32 v53, v53
    v_cvt_f32_i32 v54, v54
    v_cvt_f32_i32 v55, v55
    v_mov_b32_dpp v226, v224 row_newbcast:2 row_mask:0xf bank_mask:0xf
    v_mov_b32_dpp v227, v225 row_newbcast:2 row_mask:0xf bank_mask:0xf
    v_fma_f32 v52, v52, v226, v227
    v_fma_f32 v53, v53, v226, v227
    v_fma_f32 v54, v54, v226, v227
    v_fma_f32 v55, v55, v226, v227
    v_cvt_f32_i32 v56, v56
    v_cvt_f32_i32 v57, v57
    v_cvt_f32_i32 v58, v58
    v_cvt_f32_i32 v59, v59
    v_mov_b32_dpp v228, v224 row_newbcast:3 row_mask:0xf bank_mask:0xf
    v_mov_b32_dpp v229, v225 row_newbcast:3 row_mask:0xf bank_mask:0xf
    v_fma_f32 v56, v56, v228, v229
    v_fma_f32 v57, v57, v228, v229
    v_fma_f32 v58, v58, v228, v229
    v_fma_f32 v59, v59, v228, v229
    v_cvt_pk_bf16_f32 v205, v52, v56
    v_cvt_pk_bf16_f32 v209, v53, v57
    v_cvt_pk_bf16_f32 v45, v54, v58
    v_cvt_pk_bf16_f32 v49, v55, v59
    s_waitcnt vmcnt(8)
    v_cvt_f32_i32 v60, v60
    v_cvt_f32_i32 v61, v61
    v_cvt_f32_i32 v62, v62
    v_cvt_f32_i32 v63, v63
    v_mov_b32_dpp v226, v224 row_newbcast:4 row_mask:0xf bank_mask:0xf
    v_mov_b32_dpp v227, v225 row_newbcast:4 row_mask:0xf bank_mask:0xf
    v_fma_f32 v60, v60, v226, v227
    v_fma_f32 v61, v61, v226, v227
    v_fma_f32 v62, v62, v226, v227
    v_fma_f32 v63, v63, v226, v227
    v_cvt_f32_i32 v64, v64
    v_cvt_f32_i32 v65, v65
    v_cvt_f32_i32 v66, v66
    v_cvt_f32_i32 v67, v67
    v_mov_b32_dpp v228, v224 row_newbcast:5 row_mask:0xf bank_mask:0xf
    v_mov_b32_dpp v229, v225 row_newbcast:5 row_mask:0xf bank_mask:0xf
    v_fma_f32 v64, v64, v228, v229
    v_fma_f32 v65, v65, v228, v229
    v_fma_f32 v66, v66, v228, v229
    v_fma_f32 v67, v67, v228, v229
    v_cvt_pk_bf16_f32 v206, v60, v64
    v_cvt_pk_bf16_f32 v210, v61, v65
    v_cvt_pk_bf16_f32 v46, v62, v66
    v_cvt_pk_bf16_f32 v50, v63, v67
    s_waitcnt vmcnt(6)
    v_cvt_f32_i32 v68, v68
    v_cvt_f32_i32 v69, v69
    v_cvt_f32_i32 v70, v70
    v_cvt_f32_i32 v71, v71
    v_mov_b32_dpp v226, v224 row_newbcast:6 row_mask:0xf bank_mask:0xf
    v_mov_b32_dpp v227, v225 row_newbcast:6 row_mask:0xf bank_mask:0xf
    v_fma_f32 v68, v68, v226, v227
    v_fma_f32 v69, v69, v226, v227
    v_fma_f32 v70, v70, v226, v227
    v_fma_f32 v71, v71, v226, v227
    v_cvt_f32_i32 v72, v72
    v_cvt_f32_i32 v73, v73
    v_cvt_f32_i32 v74, v74
    v_cvt_f32_i32 v75, v75
    v_mov_b32_dpp v228, v224 row_newbcast:7 row_mask:0xf bank_mask:0xf
    v_mov_b32_dpp v229, v225 row_newbcast:7 row_mask:0xf bank_mask:0xf
    v_fma_f32 v72, v72, v228, v229
    v_fma_f32 v73, v73, v228, v229
    v_fma_f32 v74, v74, v228, v229
    v_fma_f32 v75, v75, v228, v229
    v_cvt_pk_bf16_f32 v207, v68, v72
    v_cvt_pk_bf16_f32 v211, v69, v73
    v_cvt_pk_bf16_f32 v47, v70, v74
    v_cvt_pk_bf16_f32 v51, v71, v75
    buffer_store_dwordx4 v[204:207], v4, s[28:31], s68 offen sc1
    buffer_store_dwordx4 v[208:211], v5, s[28:31], s68 offen sc1
    buffer_store_dwordx4 v[44:47], v6, s[28:31], s68 offen sc1
    buffer_store_dwordx4 v[48:51], v7, s[28:31], s68 offen sc1
    s_add_u32 s68, s68, 0x100000
    buffer_load_dwordx4 v[20:23], v246, s[40:43], s71 offen offset:128
    buffer_load_dwordx4 v[36:39], v246, s[40:43], s71 offen offset:384
    buffer_load_dwordx4 v[24:27], v246, s[40:43], s71 offen offset:192
    buffer_load_dwordx4 v[40:43], v246, s[40:43], s71 offen offset:448
    s_waitcnt vmcnt(8)
    buffer_load_dwordx4 v[140:143], v241, s[20:23], s93 offen offset:0
    buffer_load_dwordx4 v[144:147], v241, s[24:27], s93 offen offset:0
    buffer_load_dwordx4 v[148:151], v241, s[20:23], s93 offen offset:256
    buffer_load_dwordx4 v[152:155], v241, s[24:27], s93 offen offset:256
    v_readfirstlane_b32 s77, v234
    v_readfirstlane_b32 s3, v235
    s_nop 3
    s_cmp_eq_u32 s77, 0
    s_cbranch_scc1 L_tag_spin
    s_cmp_eq_u32 s3, 0
    s_cbranch_scc1 L_tag_spin
L_tag_ok:
    v_mov_b32 v254, s77
    v_mov_b32 v255, s3
    s_waitcnt vmcnt(8)
    s_mov_b64 exec, 1
    v_mov_b32 v232, 1
    ds_add_rtn_u32 v232, v253, v232
    s_waitcnt lgkmcnt(0)
    s_mov_b64 exec, -1
    v_readfirstlane_b32 s75, v232
    s_nop 3
    s_cmp_eq_u32 s75, 3
    s_cbranch_scc0 L_t3
    buffer_store_dwordx2 v[254:255], v3, s[32:35], 0 offen sc1
L_t3:
    v_accvgpr_read_b32 v212, a192
    v_accvgpr_read_b32 v213, a193
    v_accvgpr_read_b32 v214, a194
    v_accvgpr_read_b32 v215, a195
    v_accvgpr_read_b32 v216, a196
    v_accvgpr_read_b32 v217, a197
    v_accvgpr_read_b32 v218, a198
    v_accvgpr_read_b32 v219, a199
    v_lshlrev_b32 v204, 16, v212
    v_and_b32 v212, s72, v212
    v_lshlrev_b32 v205, 16, v213
    v_and_b32 v213, s72, v213
    v_lshlrev_b32 v206, 16, v214
    v_and_b32 v214, s72, v214
    v_lshlrev_b32 v207, 16, v215
    v_and_b32 v215, s72, v215
    v_lshlrev_b32 v208, 16, v216
    v_and_b32 v216, s72, v216
    v_lshlrev_b32 v209, 16, v217
    v_and_b32 v217, s72, v217
    v_lshlrev_b32 v210, 16, v218
    v_and_b32 v218, s72, v218
    v_lshlrev_b32 v211, 16, v219
    v_and_b32 v219, s72, v219
    v_lshlrev_b32 v196, 16, v12
    v_lshlrev_b32 v197, 16, v28
    v_mul_f32 v198, v196, v204
    v_mul_f32 v199, v196, v212
    v_fma_f32 v212, -v197, v212, v198
    v_fma_f32 v204, v197, v204, v199
    v_and_b32 v196, s72, v12
    v_and_b32 v197, s72, v28
    v_mul_f32 v198, v196, v205
    v_mul_f32 v199, v196, v213
    v_fma_f32 v213, -v197, v213, v198
    v_fma_f32 v205, v197, v205, v199
    v_lshlrev_b32 v196, 16, v13
    v_lshlrev_b32 v197, 16, v29
    v_mul_f32 v198, v196, v206
    v_mul_f32 v199, v196, v214
    v_fma_f32 v214, -v197, v214, v198
    v_fma_f32 v206, v197, v206, v199
    v_and_b32 v196, s72, v13
    v_and_b32 v197, s72, v29
    v_mul_f32 v198, v196, v207
    v_mul_f32 v199, v196, v215
    v_fma_f32 v215, -v197, v215, v198
    v_fma_f32 v207, v197, v207, v199
    v_lshlrev_b32 v196, 16, v14
    v_lshlrev_b32 v197, 16, v30
    v_mul_f32 v198, v196, v208
    v_mul_f32 v199, v196, v216
    v_fma_f32 v216, -v197, v216, v198
    v_fma_f32 v208, v197, v208, v199
    v_and_b32 v196, s72, v14
    v_and_b32 v197, s72, v30
    v_mul_f32 v198, v196, v209
    v_mul_f32 v199, v196, v217
    v_fma_f32 v217, -v197, v217, v198
    v_fma_f32 v209, v197, v209, v199
    v_lshlrev_b32 v196, 16, v15
    v_lshlrev_b32 v197, 16, v31
    v_mul_f32 v198, v196, v210
    v_mul_f32 v199, v196, v218
    v_fma_f32 v218, -v197, v218, v198
    v_fma_f32 v210, v197, v210, v199
    v_and_b32 v196, s72, v15
    v_and_b32 v197, s72, v31
    v_mul_f32 v198, v196, v211
    v_mul_f32 v199, v196, v219
    v_fma_f32 v219, -v197, v219, v198
    v_fma_f32 v211, v197, v211, v199
    v_cvt_pk_bf16_f32 v212, v212, v213
    v_cvt_pk_bf16_f32 v204, v204, v205
    v_cvt_pk_bf16_f32 v213, v214, v215
    v_cvt_pk_bf16_f32 v205, v206, v207
    v_cvt_pk_bf16_f32 v214, v216, v217
    v_cvt_pk_bf16_f32 v206, v208, v209
    v_cvt_pk_bf16_f32 v215, v218, v219
    v_cvt_pk_bf16_f32 v207, v210, v211
    ds_write_b128 v247, v[212:215] offset:32768
    ds_write_b128 v247, v[204:207] offset:36864
    v_accvgpr_read_b32 v212, a200
    v_accvgpr_read_b32 v213, a201
    v_accvgpr_read_b32 v214, a202
    v_accvgpr_read_b32 v215, a203
    v_accvgpr_read_b32 v216, a204
    v_accvgpr_read_b32 v217, a205
    v_accvgpr_read_b32 v218, a206
    v_accvgpr_read_b32 v219, a207
    v_lshlrev_b32 v204, 16, v212
    v_and_b32 v212, s72, v212
    v_lshlrev_b32 v205, 16, v213
    v_and_b32 v213, s72, v213
    v_lshlrev_b32 v206, 16, v214
    v_and_b32 v214, s72, v214
    v_lshlrev_b32 v207, 16, v215
    v_and_b32 v215, s72, v215
    v_lshlrev_b32 v208, 16, v216
    v_and_b32 v216, s72, v216
    v_lshlrev_b32 v209, 16, v217
    v_and_b32 v217, s72, v217
    v_lshlrev_b32 v210, 16, v218
    v_and_b32 v218, s72, v218
    v_lshlrev_b32 v211, 16, v219
    v_and_b32 v219, s72, v219
    v_lshlrev_b32 v196, 16, v16
    v_lshlrev_b32 v197, 16, v32
    v_mul_f32 v198, v196, v204
    v_mul_f32 v199, v196, v212
    v_fma_f32 v212, -v197, v212, v198
    v_fma_f32 v204, v197, v204, v199
    v_and_b32 v196, s72, v16
    v_and_b32 v197, s72, v32
    v_mul_f32 v198, v196, v205
    v_mul_f32 v199, v196, v213
    v_fma_f32 v213, -v197, v213, v198
    v_fma_f32 v205, v197, v205, v199
    v_lshlrev_b32 v196, 16, v17
    v_lshlrev_b32 v197, 16, v33
    v_mul_f32 v198, v196, v206
    v_mul_f32 v199, v196, v214
    v_fma_f32 v214, -v197, v214, v198
    v_fma_f32 v206, v197, v206, v199
    v_and_b32 v196, s72, v17
    v_and_b32 v197, s72, v33
    v_mul_f32 v198, v196, v207
    v_mul_f32 v199, v196, v215
    v_fma_f32 v215, -v197, v215, v198
    v_fma_f32 v207, v197, v207, v199
    v_lshlrev_b32 v196, 16, v18
    v_lshlrev_b32 v197, 16, v34
    v_mul_f32 v198, v196, v208
    v_mul_f32 v199, v196, v216
    v_fma_f32 v216, -v197, v216, v198
    v_fma_f32 v208, v197, v208, v199
    v_and_b32 v196, s72, v18
    v_and_b32 v197, s72, v34
    v_mul_f32 v198, v196, v209
    v_mul_f32 v199, v196, v217
    v_fma_f32 v217, -v197, v217, v198
    v_fma_f32 v209, v197, v209, v199
    v_lshlrev_b32 v196, 16, v19
    v_lshlrev_b32 v197, 16, v35
    v_mul_f32 v198, v196, v210
    v_mul_f32 v199, v196, v218
    v_fma_f32 v218, -v197, v218, v198
    v_fma_f32 v210, v197, v210, v199
    v_and_b32 v196, s72, v19
    v_and_b32 v197, s72, v35
    v_mul_f32 v198, v196, v211
    v_mul_f32 v199, v196, v219
    v_fma_f32 v219, -v197, v219, v198
    v_fma_f32 v211, v197, v211, v199
    v_cvt_pk_bf16_f32 v212, v212, v213
    v_cvt_pk_bf16_f32 v204, v204, v205
    v_cvt_pk_bf16_f32 v213, v214, v215
    v_cvt_pk_bf16_f32 v205, v206, v207
    v_cvt_pk_bf16_f32 v214, v216, v217
    v_cvt_pk_bf16_f32 v206, v208, v209
    v_cvt_pk_bf16_f32 v215, v218, v219
    v_cvt_pk_bf16_f32 v207, v210, v211
    ds_write_b128 v247, v[212:215] offset:33792
    ds_write_b128 v247, v[204:207] offset:37888
    s_waitcnt vmcnt(4)
    buffer_load_dwordx2 v[188:189], v242, s[12:15], s92 offen
    buffer_load_dwordx2 v[190:191], v242, s[16:19], s92 offen
    buffer_load_dwordx4 v[108:111], v240, s[8:11], s91 offen offset:0
    buffer_load_dwordx4 v[112:115], v240, s[8:11], s91 offen offset:16
    buffer_load_dwordx4 v[116:119], v240, s[8:11], s91 offen offset:512
    buffer_load_dwordx4 v[120:123], v240, s[8:11], s91 offen offset:528
    s_add_u32 s91, s91, 0x200000
    s_add_u32 s92, s92, 0x4000
    v_accvgpr_read_b32 v212, a208
    v_accvgpr_read_b32 v213, a209
    v_accvgpr_read_b32 v214, a210
    v_accvgpr_read_b32 v215, a211
    v_accvgpr_read_b32 v216, a212
    v_accvgpr_read_b32 v217, a213
    v_accvgpr_read_b32 v218, a214
    v_accvgpr_read_b32 v219, a215
    v_lshlrev_b32 v204, 16, v212
    v_and_b32 v212, s72, v212
    v_lshlrev_b32 v205, 16, v213
    v_and_b32 v213, s72, v213
    v_lshlrev_b32 v206, 16, v214
    v_and_b32 v214, s72, v214
    v_lshlrev_b32 v207, 16, v215
    v_and_b32 v215, s72, v215
    v_lshlrev_b32 v208, 16, v216
    v_and_b32 v216, s72, v216
    v_lshlrev_b32 v209, 16, v217
    v_and_b32 v217, s72, v217
    v_lshlrev_b32 v210, 16, v218
    v_and_b32 v218, s72, v218
    v_lshlrev_b32 v211, 16, v219
    v_and_b32 v219, s72, v219
    v_lshlrev_b32 v196, 16, v20
    v_lshlrev_b32 v197, 16, v36
    v_mul_f32 v198, v196, v204
    v_mul_f32 v199, v196, v212
    v_fma_f32 v212, -v197, v212, v198
    v_fma_f32 v204, v197, v204, v199
    v_and_b32 v196, s72, v20
    v_and_b32 v197, s72, v36
    v_mul_f32 v198, v196, v205
    v_mul_f32 v199, v196, v213
    v_fma_f32 v213, -v197, v213, v198
    v_fma_f32 v205, v197, v205, v199
    v_lshlrev_b32 v196, 16, v21
    v_lshlrev_b32 v197, 16, v37
    v_mul_f32 v198, v196, v206
    v_mul_f32 v199, v196, v214
    v_fma_f32 v214, -v197, v214, v198
    v_fma_f32 v206, v197, v206, v199
    v_and_b32 v196, s72, v21
    v_and_b32 v197, s72, v37
    v_mul_f32 v198, v196, v207
    v_mul_f32 v199, v196, v215
    v_fma_f32 v215, -v197, v215, v198
    v_fma_f32 v207, v197, v207, v199
    v_lshlrev_b32 v196, 16, v22
    v_lshlrev_b32 v197, 16, v38
    v_mul_f32 v198, v196, v208
    v_mul_f32 v199, v196, v216
    v_fma_f32 v216, -v197, v216, v198
    v_fma_f32 v208, v197, v208, v199
    v_and_b32 v196, s72, v22
    v_and_b32 v197, s72, v38
    v_mul_f32 v198, v196, v209
    v_mul_f32 v199, v196, v217
    v_fma_f32 v217, -v197, v217, v198
    v_fma_f32 v209, v197, v209, v199
    v_lshlrev_b32 v196, 16, v23
    v_lshlrev_b32 v197, 16, v39
    v_mul_f32 v198, v196, v210
    v_mul_f32 v199, v196, v218
    v_fma_f32 v218, -v197, v218, v198
    v_fma_f32 v210, v197, v210, v199
    v_and_b32 v196, s72, v23
    v_and_b32 v197, s72, v39
    v_mul_f32 v198, v196, v211
    v_mul_f32 v199, v196, v219
    v_fma_f32 v219, -v197, v219, v198
    v_fma_f32 v211, v197, v211, v199
    v_cvt_pk_bf16_f32 v212, v212, v213
    v_cvt_pk_bf16_f32 v204, v204, v205
    v_cvt_pk_bf16_f32 v213, v214, v215
    v_cvt_pk_bf16_f32 v205, v206, v207
    v_cvt_pk_bf16_f32 v214, v216, v217
    v_cvt_pk_bf16_f32 v206, v208, v209
    v_cvt_pk_bf16_f32 v215, v218, v219
    v_cvt_pk_bf16_f32 v207, v210, v211
    ds_write_b128 v247, v[212:215] offset:34816
    ds_write_b128 v247, v[204:207] offset:38912
    v_accvgpr_read_b32 v212, a216
    v_accvgpr_read_b32 v213, a217
    v_accvgpr_read_b32 v214, a218
    v_accvgpr_read_b32 v215, a219
    v_accvgpr_read_b32 v216, a220
    v_accvgpr_read_b32 v217, a221
    v_accvgpr_read_b32 v218, a222
    v_accvgpr_read_b32 v219, a223
    v_lshlrev_b32 v204, 16, v212
    v_and_b32 v212, s72, v212
    v_lshlrev_b32 v205, 16, v213
    v_and_b32 v213, s72, v213
    v_lshlrev_b32 v206, 16, v214
    v_and_b32 v214, s72, v214
    v_lshlrev_b32 v207, 16, v215
    v_and_b32 v215, s72, v215
    v_lshlrev_b32 v208, 16, v216
    v_and_b32 v216, s72, v216
    v_lshlrev_b32 v209, 16, v217
    v_and_b32 v217, s72, v217
    v_lshlrev_b32 v210, 16, v218
    v_and_b32 v218, s72, v218
    v_lshlrev_b32 v211, 16, v219
    v_and_b32 v219, s72, v219
    v_lshlrev_b32 v196, 16, v24
    v_lshlrev_b32 v197, 16, v40
    v_mul_f32 v198, v196, v204
    v_mul_f32 v199, v196, v212
    v_fma_f32 v212, -v197, v212, v198
    v_fma_f32 v204, v197, v204, v199
    v_and_b32 v196, s72, v24
    v_and_b32 v197, s72, v40
    v_mul_f32 v198, v196, v205
    v_mul_f32 v199, v196, v213
    v_fma_f32 v213, -v197, v213, v198
    v_fma_f32 v205, v197, v205, v199
    v_lshlrev_b32 v196, 16, v25
    v_lshlrev_b32 v197, 16, v41
    v_mul_f32 v198, v196, v206
    v_mul_f32 v199, v196, v214
    v_fma_f32 v214, -v197, v214, v198
    v_fma_f32 v206, v197, v206, v199
    v_and_b32 v196, s72, v25
    v_and_b32 v197, s72, v41
    v_mul_f32 v198, v196, v207
    v_mul_f32 v199, v196, v215
    v_fma_f32 v215, -v197, v215, v198
    v_fma_f32 v207, v197, v207, v199
    v_lshlrev_b32 v196, 16, v26
    v_lshlrev_b32 v197, 16, v42
    v_mul_f32 v198, v196, v208
    v_mul_f32 v199, v196, v216
    v_fma_f32 v216, -v197, v216, v198
    v_fma_f32 v208, v197, v208, v199
    v_and_b32 v196, s72, v26
    v_and_b32 v197, s72, v42
    v_mul_f32 v198, v196, v209
    v_mul_f32 v199, v196, v217
    v_fma_f32 v217, -v197, v217, v198
    v_fma_f32 v209, v197, v209, v199
    v_lshlrev_b32 v196, 16, v27
    v_lshlrev_b32 v197, 16, v43
    v_mul_f32 v198, v196, v210
    v_mul_f32 v199, v196, v218
    v_fma_f32 v218, -v197, v218, v198
    v_fma_f32 v210, v197, v210, v199
    v_and_b32 v196, s72, v27
    v_and_b32 v197, s72, v43
    v_mul_f32 v198, v196, v211
    v_mul_f32 v199, v196, v219
    v_fma_f32 v219, -v197, v219, v198
    v_fma_f32 v211, v197, v211, v199
    v_cvt_pk_bf16_f32 v212, v212, v213
    v_cvt_pk_bf16_f32 v204, v204, v205
    v_cvt_pk_bf16_f32 v213, v214, v215
    v_cvt_pk_bf16_f32 v205, v206, v207
    v_cvt_pk_bf16_f32 v214, v216, v217
    v_cvt_pk_bf16_f32 v206, v208, v209
    v_cvt_pk_bf16_f32 v215, v218, v219
    v_cvt_pk_bf16_f32 v207, v210, v211
    ds_write_b128 v247, v[212:215] offset:35840
    ds_write_b128 v247, v[204:207] offset:39936
    s_cmp_eq_u32 s89, 1
    s_cbranch_scc1 L_table_rope
L_table_back:
    v_mov_b32 v8, 0x3f803f80
    v_mov_b32 v9, 0x3f803f80
    v_mov_b32 v10, 0x3f803f80
    v_mov_b32 v11, 0x3f803f80
    v_mov_b32 v12, 0
    v_mov_b32 v13, 0
    v_mov_b32 v14, 0
    v_mov_b32 v15, 0
    v_mov_b32 v16, 0
    v_mov_b32 v17, 0
    v_mov_b32 v18, 0
    v_mov_b32 v19, 0
    v_mov_b32 v20, 0
    v_mov_b32 v21, 0
    v_mov_b32 v22, 0
    v_mov_b32 v23, 0
    v_mov_b32 v24, 0
    v_mov_b32 v25, 0
    v_mov_b32 v26, 0
    v_mov_b32 v27, 0
    v_mov_b32 v28, 0
    v_mov_b32 v29, 0
    v_mov_b32 v30, 0
    v_mov_b32 v31, 0
    v_mov_b32 v32, 0
    v_mov_b32 v33, 0
    v_mov_b32 v34, 0
    v_mov_b32 v35, 0
    v_mov_b32 v36, 0
    v_mov_b32 v37, 0
    v_mov_b32 v38, 0
    v_mov_b32 v39, 0
    v_mov_b32 v40, 0
    v_mov_b32 v41, 0
    v_mov_b32 v42, 0
    v_mov_b32 v43, 0
    v_and_b32 v249, 15, v0
    v_lshrrev_b32 v253, 4, v0
    v_lshlrev_b32 v246, 4, v249
    s_lshl_b32 s76, s100, 2
    v_add_u32 v247, s76, v246
    s_lshl_b32 s75, s98, 15
    s_lshl_b32 s76, s101, 20
    s_add_u32 s75, s75, s76
    s_lshl_b32 s76, s100, 7
    s_add_u32 s75, s75, s76
    v_lshl_add_u32 v251, v249, 3, s75
    v_lshl_add_u32 v251, v253, 11, v251
    s_lshl_b32 s76, s100, 8
    v_lshl_add_u32 v249, v249, 2, s76
    v_lshl_add_u32 v253, v253, 4, s76
    s_waitcnt vmcnt(6)
    buffer_load_dwordx2 v[192:193], v242, s[12:15], s92 offen
    buffer_load_dwordx2 v[194:195], v242, s[16:19], s92 offen
    buffer_load_dwordx4 v[124:127], v240, s[8:11], s91 offen offset:0
    buffer_load_dwordx4 v[128:131], v240, s[8:11], s91 offen offset:16
    buffer_load_dwordx4 v[132:135], v240, s[8:11], s91 offen offset:512
    buffer_load_dwordx4 v[136:139], v240, s[8:11], s91 offen offset:528
    v_lshlrev_b32 v156, 16, v140
    v_and_b32 v157, s72, v140
    v_lshlrev_b32 v158, 16, v141
    v_and_b32 v159, s72, v141
    v_lshlrev_b32 v160, 16, v142
    v_and_b32 v161, s72, v142
    v_lshlrev_b32 v162, 16, v143
    v_and_b32 v163, s72, v143
    v_lshlrev_b32 v164, 16, v144
    v_and_b32 v165, s72, v144
    v_lshlrev_b32 v166, 16, v145
    v_and_b32 v167, s72, v145
    v_lshlrev_b32 v168, 16, v146
    v_and_b32 v169, s72, v146
    v_lshlrev_b32 v170, 16, v147
    v_and_b32 v171, s72, v147
    v_lshlrev_b32 v172, 16, v148
    v_and_b32 v173, s72, v148
    v_lshlrev_b32 v174, 16, v149
    v_and_b32 v175, s72, v149
    v_lshlrev_b32 v176, 16, v150
    v_and_b32 v177, s72, v150
    v_lshlrev_b32 v178, 16, v151
    v_and_b32 v179, s72, v151
    v_lshlrev_b32 v180, 16, v152
    v_and_b32 v181, s72, v152
    v_lshlrev_b32 v182, 16, v153
    v_and_b32 v183, s72, v153
    v_lshlrev_b32 v184, 16, v154
    v_and_b32 v185, s72, v154
    v_lshlrev_b32 v186, 16, v155
    v_and_b32 v187, s72, v155
    s_waitcnt vmcnt(6)
    buffer_load_dword v222, v245, s[60:63], s97 offen
    buffer_load_dword v223, v245, s[64:67], s97 offen
    buffer_load_dwordx4 v[76:79], v244, s[56:59], s95 offen offset:0
    buffer_load_dwordx4 v[80:83], v244, s[56:59], s95 offen offset:1024
    buffer_load_dwordx4 v[84:87], v244, s[56:59], s95 offen offset:2048
    buffer_load_dwordx4 v[88:91], v244, s[56:59], s95 offen offset:3072
    v_perm_b32 v188, v188, v188, s73
    v_perm_b32 v189, v189, v189, s73
    v_perm_b32 v190, v190, v190, s73
    v_perm_b32 v191, v191, v191, s73
    v_mul_f32 v188, s74, v188
    v_mul_f32 v189, s74, v189
    v_mul_f32 v190, -v190, v188
    v_mul_f32 v191, -v191, v189
    v_cvt_f32_i32 v108, v108
    v_cvt_f32_i32 v116, v116
    v_fma_f32 v108, v108, v188, v190
    v_fma_f32 v116, v116, v189, v191
    v_mul_f32 v230, v156, v108
    v_mul_f32 v231, v180, v108
    v_fma_f32 v108, -v116, v164, v230
    v_fma_f32 v116, v116, v172, v231
    v_cvt_f32_i32 v109, v109
    v_cvt_f32_i32 v117, v117
    v_fma_f32 v109, v109, v188, v190
    v_fma_f32 v117, v117, v189, v191
    v_mul_f32 v230, v157, v109
    v_mul_f32 v231, v181, v109
    v_fma_f32 v109, -v117, v165, v230
    v_fma_f32 v117, v117, v173, v231
    v_cvt_pk_bf16_f32 v108, v108, v109
    v_cvt_pk_bf16_f32 v116, v116, v117
    v_cvt_f32_i32 v110, v110
    v_cvt_f32_i32 v118, v118
    v_fma_f32 v110, v110, v188, v190
    v_fma_f32 v118, v118, v189, v191
    v_mul_f32 v230, v158, v110
    v_mul_f32 v231, v182, v110
    v_fma_f32 v110, -v118, v166, v230
    v_fma_f32 v118, v118, v174, v231
    v_cvt_f32_i32 v111, v111
    v_cvt_f32_i32 v119, v119
    v_fma_f32 v111, v111, v188, v190
    v_fma_f32 v119, v119, v189, v191
    v_mul_f32 v230, v159, v111
    v_mul_f32 v231, v183, v111
    v_fma_f32 v111, -v119, v167, v230
    v_fma_f32 v119, v119, v175, v231
    v_cvt_pk_bf16_f32 v109, v110, v111
    v_cvt_pk_bf16_f32 v117, v118, v119
    v_cvt_f32_i32 v112, v112
    v_cvt_f32_i32 v120, v120
    v_fma_f32 v112, v112, v188, v190
    v_fma_f32 v120, v120, v189, v191
    v_mul_f32 v230, v160, v112
    v_mul_f32 v231, v184, v112
    v_fma_f32 v112, -v120, v168, v230
    v_fma_f32 v120, v120, v176, v231
    v_cvt_f32_i32 v113, v113
    v_cvt_f32_i32 v121, v121
    v_fma_f32 v113, v113, v188, v190
    v_fma_f32 v121, v121, v189, v191
    v_mul_f32 v230, v161, v113
    v_mul_f32 v231, v185, v113
    v_fma_f32 v113, -v121, v169, v230
    v_fma_f32 v121, v121, v177, v231
    v_cvt_pk_bf16_f32 v110, v112, v113
    v_cvt_pk_bf16_f32 v118, v120, v121
    v_cvt_f32_i32 v114, v114
    v_cvt_f32_i32 v122, v122
    v_fma_f32 v114, v114, v188, v190
    v_fma_f32 v122, v122, v189, v191
    v_mul_f32 v230, v162, v114
    v_mul_f32 v231, v186, v114
    v_fma_f32 v114, -v122, v170, v230
    v_fma_f32 v122, v122, v178, v231
    v_cvt_f32_i32 v115, v115
    v_cvt_f32_i32 v123, v123
    v_fma_f32 v115, v115, v188, v190
    v_fma_f32 v123, v123, v189, v191
    v_mul_f32 v230, v163, v115
    v_mul_f32 v231, v187, v115
    v_fma_f32 v115, -v123, v171, v230
    v_fma_f32 v123, v123, v179, v231
    v_cvt_pk_bf16_f32 v111, v114, v115
    v_cvt_pk_bf16_f32 v119, v122, v123
    buffer_store_dwordx4 v[108:111], v243, s[28:31], s94 offen sc1
    buffer_store_dwordx4 v[116:119], v248, s[28:31], s94 offen sc1
    s_add_u32 s94, s94, 0x200000
    s_waitcnt vmcnt(8)
    buffer_load_dwordx4 v[92:95], v244, s[56:59], s96 offen offset:0
    buffer_load_dwordx4 v[96:99], v244, s[56:59], s96 offen offset:1024
    buffer_load_dwordx4 v[100:103], v244, s[56:59], s96 offen offset:2048
    buffer_load_dwordx4 v[104:107], v244, s[56:59], s96 offen offset:3072
    s_getpc_b64 s[80:81]
L_pf_b:
    s_lshl_b32 s82, s98, 2
    s_add_u32 s82, s82, s100
    s_min_u32 s82, s82, 9
    s_add_u32 s82, s82, 11
    s_lshl_b32 s82, s82, 10
    s_sub_u32 s82, s82, L_pf_b - standalone__kv_cache_quant_pre_rope_vs_post_rope__prompt_kernel
    s_ashr_i32 s83, s82, 31
    s_add_u32 s80, s80, s82
    s_addc_u32 s81, s81, s83
    v_lshlrev_b32 v202, 4, v0
    v_mov_b32 v203, s81
    v_add_co_u32 v202, vcc, s80, v202
    s_nop 1
    v_addc_co_u32 v203, vcc, 0, v203, vcc
    global_load_dwordx4 a[252:255], v[202:203], off
    v_perm_b32 v192, v192, v192, s73
    v_perm_b32 v193, v193, v193, s73
    v_perm_b32 v194, v194, v194, s73
    v_perm_b32 v195, v195, v195, s73
    v_mul_f32 v192, s74, v192
    v_mul_f32 v193, s74, v193
    v_mul_f32 v194, -v194, v192
    v_mul_f32 v195, -v195, v193
    v_cvt_f32_i32 v124, v124
    v_cvt_f32_i32 v132, v132
    v_fma_f32 v124, v124, v192, v194
    v_fma_f32 v132, v132, v193, v195
    v_mul_f32 v230, v156, v124
    v_mul_f32 v231, v180, v124
    v_fma_f32 v124, -v132, v164, v230
    v_fma_f32 v132, v132, v172, v231
    v_cvt_f32_i32 v125, v125
    v_cvt_f32_i32 v133, v133
    v_fma_f32 v125, v125, v192, v194
    v_fma_f32 v133, v133, v193, v195
    v_mul_f32 v230, v157, v125
    v_mul_f32 v231, v181, v125
    v_fma_f32 v125, -v133, v165, v230
    v_fma_f32 v133, v133, v173, v231
    v_cvt_pk_bf16_f32 v124, v124, v125
    v_cvt_pk_bf16_f32 v132, v132, v133
    v_cvt_f32_i32 v126, v126
    v_cvt_f32_i32 v134, v134
    v_fma_f32 v126, v126, v192, v194
    v_fma_f32 v134, v134, v193, v195
    v_mul_f32 v230, v158, v126
    v_mul_f32 v231, v182, v126
    v_fma_f32 v126, -v134, v166, v230
    v_fma_f32 v134, v134, v174, v231
    v_cvt_f32_i32 v127, v127
    v_cvt_f32_i32 v135, v135
    v_fma_f32 v127, v127, v192, v194
    v_fma_f32 v135, v135, v193, v195
    v_mul_f32 v230, v159, v127
    v_mul_f32 v231, v183, v127
    v_fma_f32 v127, -v135, v167, v230
    v_fma_f32 v135, v135, v175, v231
    v_cvt_pk_bf16_f32 v125, v126, v127
    v_cvt_pk_bf16_f32 v133, v134, v135
    v_cvt_f32_i32 v128, v128
    v_cvt_f32_i32 v136, v136
    v_fma_f32 v128, v128, v192, v194
    v_fma_f32 v136, v136, v193, v195
    v_mul_f32 v230, v160, v128
    v_mul_f32 v231, v184, v128
    v_fma_f32 v128, -v136, v168, v230
    v_fma_f32 v136, v136, v176, v231
    v_cvt_f32_i32 v129, v129
    v_cvt_f32_i32 v137, v137
    v_fma_f32 v129, v129, v192, v194
    v_fma_f32 v137, v137, v193, v195
    v_mul_f32 v230, v161, v129
    v_mul_f32 v231, v185, v129
    v_fma_f32 v129, -v137, v169, v230
    v_fma_f32 v137, v137, v177, v231
    v_cvt_pk_bf16_f32 v126, v128, v129
    v_cvt_pk_bf16_f32 v134, v136, v137
    v_cvt_f32_i32 v130, v130
    v_cvt_f32_i32 v138, v138
    v_fma_f32 v130, v130, v192, v194
    v_fma_f32 v138, v138, v193, v195
    v_mul_f32 v230, v162, v130
    v_mul_f32 v231, v186, v130
    v_fma_f32 v130, -v138, v170, v230
    v_fma_f32 v138, v138, v178, v231
    v_cvt_f32_i32 v131, v131
    v_cvt_f32_i32 v139, v139
    v_fma_f32 v131, v131, v192, v194
    v_fma_f32 v139, v139, v193, v195
    v_mul_f32 v230, v163, v131
    v_mul_f32 v231, v187, v131
    v_fma_f32 v131, -v139, v171, v230
    v_fma_f32 v139, v139, v179, v231
    v_cvt_pk_bf16_f32 v127, v130, v131
    v_cvt_pk_bf16_f32 v135, v138, v139
    s_nop 1
    v_mov_b32 v140, 0
    v_mov_b32 v141, 0
    v_mov_b32 v142, 0
    v_mov_b32 v143, 0
    v_mov_b32 v144, 0
    v_mov_b32 v145, 0
    v_mov_b32 v146, 0
    v_mov_b32 v147, 0
    v_mov_b32 v148, 0
    v_mov_b32 v149, 0
    v_mov_b32 v150, 0
    v_mov_b32 v151, 0
    v_mov_b32 v152, 0
    v_mov_b32 v153, 0
    v_mov_b32 v154, 0
    v_mov_b32 v155, 0
    v_mov_b32 v156, 0
    v_mov_b32 v157, 0
    v_mov_b32 v158, 0
    v_mov_b32 v159, 0
    v_mov_b32 v160, 0
    v_mov_b32 v161, 0
    v_mov_b32 v162, 0
    v_mov_b32 v163, 0
    v_mov_b32 v164, 0
    v_mov_b32 v165, 0
    v_mov_b32 v166, 0
    v_mov_b32 v167, 0
    v_mov_b32 v168, 0
    v_mov_b32 v169, 0
    v_mov_b32 v170, 0
    v_mov_b32 v171, 0
    v_mov_b32 v172, 0
    v_mov_b32 v173, 0
    v_mov_b32 v174, 0
    v_mov_b32 v175, 0
    v_mov_b32 v176, 0
    v_mov_b32 v177, 0
    v_mov_b32 v178, 0
    v_mov_b32 v179, 0
    v_mov_b32 v180, 0
    v_mov_b32 v181, 0
    v_mov_b32 v182, 0
    v_mov_b32 v183, 0
    v_mov_b32 v184, 0
    v_mov_b32 v185, 0
    v_mov_b32 v186, 0
    v_mov_b32 v187, 0
    v_mov_b32 v188, 0
    v_mov_b32 v189, 0
    v_mov_b32 v190, 0
    v_mov_b32 v191, 0
    v_mov_b32 v192, 0
    v_mov_b32 v193, 0
    v_mov_b32 v194, 0
    v_mov_b32 v195, 0
    v_mov_b32 v196, 0
    v_mov_b32 v197, 0
    v_mov_b32 v198, 0
    v_mov_b32 v199, 0
    v_mov_b32 v200, 0
    v_mov_b32 v201, 0
    v_mov_b32 v202, 0
    v_mov_b32 v203, 0
    s_lshl_b32 s75, s100, 15
    s_add_u32 s8, s4, s75
    s_addc_u32 s9, s5, 0x100000
    s_mov_b32 s10, 0x20000
    s_mov_b32 s11, 0x800000
    s_add_u32 s75, s75, 0x1000
    s_add_u32 s12, s4, s75
    s_addc_u32 s13, s5, 0x100000
    s_mov_b32 s14, 0x20000
    s_mov_b32 s15, 0x800000
    s_add_u32 s75, s75, 0x1000
    s_add_u32 s16, s4, s75
    s_addc_u32 s17, s5, 0x100000
    s_mov_b32 s18, 0x20000
    s_mov_b32 s19, 0x800000
    s_add_u32 s75, s75, 0x1000
    s_add_u32 s20, s4, s75
    s_addc_u32 s21, s5, 0x100000
    s_mov_b32 s22, 0x20000
    s_mov_b32 s23, 0x800000
    s_cmp_eq_u32 s100, 0
    s_cbranch_scc0 L_t4
    buffer_load_dwordx4 v[232:235], v1, s[32:35], 0 offen offset:0 sc1
    buffer_load_dwordx4 v[236:239], v1, s[32:35], 0 offen offset:1024 sc1
L_t4:
    s_cmp_eq_u32 s100, 0
    s_cbranch_scc0 L_t5
    s_waitcnt vmcnt(0)
    v_xor_b32 v232, s77, v232
    v_xor_b32 v233, s3, v233
    v_xor_b32 v234, s77, v234
    v_xor_b32 v235, s3, v235
    v_xor_b32 v236, s77, v236
    v_xor_b32 v237, s3, v237
    v_xor_b32 v238, s77, v238
    v_xor_b32 v239, s3, v239
    v_or3_b32 v232, v232, v233, v234
    v_or3_b32 v235, v235, v236, v237
    v_or3_b32 v232, v232, v238, v239
    v_or_b32 v232, v232, v235
    v_cmp_eq_u32 vcc, 0, v232
    s_nop 3
    s_cmp_eq_u64 vcc, -1
    s_cbranch_scc0 L_spin0
L_spin0_back:
L_t5:
    s_waitcnt lgkmcnt(0)
    s_barrier
    s_mov_b64 s[92:93], s[84:85]
    s_and_b32 s69, s92, 15
    s_lshl_b32 s69, s69, 17
    s_mov_b64 s[96:97], s[84:85]
    s_and_b32 s70, s96, 15
    s_lshl_b32 s70, s70, 17
    s_or_b32 s70, s70, 0x4000
    buffer_load_dwordx4 a[128:131], off, s[8:11], s69 offset:0 sc1
    ds_read_b128 a[0:3], v1 offset:32768
    ds_read_b128 a[32:35], v1 offset:40960
    buffer_load_dwordx4 a[132:135], off, s[8:11], s69 offset:1024 sc1
    ds_read_b128 a[64:67], v1 offset:49152
    ds_read_b128 a[96:99], v1 offset:57344
    buffer_load_dwordx4 a[136:139], off, s[8:11], s69 offset:2048 sc1
    ds_read_b128 a[4:7], v1 offset:33792
    ds_read_b128 a[36:39], v1 offset:41984
    buffer_load_dwordx4 a[140:143], off, s[8:11], s69 offset:3072 sc1
    ds_read_b128 a[68:71], v1 offset:50176
    ds_read_b128 a[100:103], v1 offset:58368
    buffer_load_dwordx4 a[144:147], off, s[12:15], s69 offset:0 sc1
    ds_read_b128 a[8:11], v1 offset:34816
    ds_read_b128 a[40:43], v1 offset:43008
    buffer_load_dwordx4 a[148:151], off, s[12:15], s69 offset:1024 sc1
    ds_read_b128 a[72:75], v1 offset:51200
    ds_read_b128 a[104:107], v1 offset:59392
    s_waitcnt vmcnt(15)
    v_perm_b32 v224, v222, v222, s88
    v_perm_b32 v225, v223, v223, s88
    buffer_load_dwordx4 a[152:155], off, s[12:15], s69 offset:2048 sc1
    v_mul_f32 v225, -v225, v224
    v_cvt_f32_i32 v76, v76
    ds_read_b128 a[12:15], v1 offset:35840
    v_cvt_f32_i32 v77, v77
    v_cvt_f32_i32 v78, v78
    ds_read_b128 a[44:47], v1 offset:44032
    v_cvt_f32_i32 v79, v79
    v_mov_b32_dpp v226, v224 row_newbcast:0 row_mask:0xf bank_mask:0xf
    buffer_load_dwordx4 a[156:159], off, s[12:15], s69 offset:3072 sc1
    v_mov_b32_dpp v227, v225 row_newbcast:0 row_mask:0xf bank_mask:0xf
    v_fma_f32 v76, v76, v226, v227
    ds_read_b128 a[76:79], v1 offset:52224
    v_fma_f32 v77, v77, v226, v227
    v_fma_f32 v78, v78, v226, v227
    ds_read_b128 a[108:111], v1 offset:60416
    v_fma_f32 v79, v79, v226, v227
    v_cvt_f32_i32 v80, v80
    buffer_load_dwordx4 a[160:163], off, s[16:19], s69 offset:0 sc1
    v_cvt_f32_i32 v81, v81
    v_cvt_f32_i32 v82, v82
    ds_read_b128 a[16:19], v1 offset:36864
    v_cvt_f32_i32 v83, v83
    v_mov_b32_dpp v228, v224 row_newbcast:1 row_mask:0xf bank_mask:0xf
    ds_read_b128 a[48:51], v1 offset:45056
    v_mov_b32_dpp v229, v225 row_newbcast:1 row_mask:0xf bank_mask:0xf
    v_fma_f32 v80, v80, v228, v229
    buffer_load_dwordx4 a[164:167], off, s[16:19], s69 offset:1024 sc1
    v_fma_f32 v81, v81, v228, v229
    v_fma_f32 v82, v82, v228, v229
    ds_read_b128 a[80:83], v1 offset:53248
    v_fma_f32 v83, v83, v228, v229
    v_cvt_pk_bf16_f32 v212, v76, v80
    ds_read_b128 a[112:115], v1 offset:61440
    v_cvt_pk_bf16_f32 v216, v77, v81
    v_cvt_pk_bf16_f32 v76, v78, v82
    buffer_load_dwordx4 a[168:171], off, s[16:19], s69 offset:2048 sc1
    v_cvt_pk_bf16_f32 v80, v79, v83
    s_waitcnt vmcnt(18)
    v_cvt_f32_i32 v84, v84
    ds_read_b128 a[20:23], v1 offset:37888
    v_cvt_f32_i32 v85, v85
    v_cvt_f32_i32 v86, v86
    ds_read_b128 a[52:55], v1 offset:46080
    v_cvt_f32_i32 v87, v87
    v_mov_b32_dpp v226, v224 row_newbcast:2 row_mask:0xf bank_mask:0xf
    buffer_load_dwordx4 a[172:175], off, s[16:19], s69 offset:3072 sc1
    v_mov_b32_dpp v227, v225 row_newbcast:2 row_mask:0xf bank_mask:0xf
    v_fma_f32 v84, v84, v226, v227
    ds_read_b128 a[84:87], v1 offset:54272
    v_fma_f32 v85, v85, v226, v227
    v_fma_f32 v86, v86, v226, v227
    ds_read_b128 a[116:119], v1 offset:62464
    v_fma_f32 v87, v87, v226, v227
    v_cvt_f32_i32 v88, v88
    buffer_load_dwordx4 a[176:179], off, s[20:23], s69 offset:0 sc1
    v_cvt_f32_i32 v89, v89
    v_cvt_f32_i32 v90, v90
    ds_read_b128 a[24:27], v1 offset:38912
    v_cvt_f32_i32 v91, v91
    v_mov_b32_dpp v228, v224 row_newbcast:3 row_mask:0xf bank_mask:0xf
    ds_read_b128 a[56:59], v1 offset:47104
    v_mov_b32_dpp v229, v225 row_newbcast:3 row_mask:0xf bank_mask:0xf
    v_fma_f32 v88, v88, v228, v229
    buffer_load_dwordx4 a[180:183], off, s[20:23], s69 offset:1024 sc1
    v_fma_f32 v89, v89, v228, v229
    v_fma_f32 v90, v90, v228, v229
    ds_read_b128 a[88:91], v1 offset:55296
    v_fma_f32 v91, v91, v228, v229
    v_cvt_pk_bf16_f32 v213, v84, v88
    ds_read_b128 a[120:123], v1 offset:63488
    v_cvt_pk_bf16_f32 v217, v85, v89
    v_cvt_pk_bf16_f32 v77, v86, v90
    buffer_load_dwordx4 a[184:187], off, s[20:23], s69 offset:2048 sc1
    v_cvt_pk_bf16_f32 v81, v87, v91
    s_waitcnt vmcnt(18)
    v_cvt_f32_i32 v92, v92
    ds_read_b128 a[28:31], v1 offset:39936
    v_cvt_f32_i32 v93, v93
    v_cvt_f32_i32 v94, v94
    ds_read_b128 a[60:63], v1 offset:48128
    v_cvt_f32_i32 v95, v95
    v_mov_b32_dpp v226, v224 row_newbcast:4 row_mask:0xf bank_mask:0xf
    buffer_load_dwordx4 a[188:191], off, s[20:23], s69 offset:3072 sc1
    v_mov_b32_dpp v227, v225 row_newbcast:4 row_mask:0xf bank_mask:0xf
    v_fma_f32 v92, v92, v226, v227
    ds_read_b128 a[92:95], v1 offset:56320
    v_fma_f32 v93, v93, v226, v227
    v_fma_f32 v94, v94, v226, v227
    ds_read_b128 a[124:127], v1 offset:64512
    v_fma_f32 v95, v95, v226, v227
    v_cvt_f32_i32 v96, v96
    s_lshr_b64 s[92:93], s[92:93], 4
    v_cvt_f32_i32 v97, v97
    v_cvt_f32_i32 v98, v98
    s_and_b32 s69, s92, 15
    v_cvt_f32_i32 v99, v99
    v_mov_b32_dpp v228, v224 row_newbcast:5 row_mask:0xf bank_mask:0xf
    s_lshl_b32 s69, s69, 17
    v_mov_b32_dpp v229, v225 row_newbcast:5 row_mask:0xf bank_mask:0xf
    v_fma_f32 v96, v96, v228, v229
    v_fma_f32 v97, v97, v228, v229
    v_fma_f32 v98, v98, v228, v229
    v_fma_f32 v99, v99, v228, v229
    v_cvt_pk_bf16_f32 v214, v92, v96
    v_cvt_pk_bf16_f32 v218, v93, v97
    v_cvt_pk_bf16_f32 v78, v94, v98
    v_cvt_pk_bf16_f32 v82, v95, v99
    s_waitcnt vmcnt(17)
    v_cvt_f32_i32 v100, v100
    v_cvt_f32_i32 v101, v101
    v_cvt_f32_i32 v102, v102
    v_cvt_f32_i32 v103, v103
    v_mov_b32_dpp v226, v224 row_newbcast:6 row_mask:0xf bank_mask:0xf
    v_mov_b32_dpp v227, v225 row_newbcast:6 row_mask:0xf bank_mask:0xf
    v_fma_f32 v100, v100, v226, v227
    v_fma_f32 v101, v101, v226, v227
    v_fma_f32 v102, v102, v226, v227
    v_fma_f32 v103, v103, v226, v227
    v_cvt_f32_i32 v104, v104
    v_cvt_f32_i32 v105, v105
    v_cvt_f32_i32 v106, v106
    v_cvt_f32_i32 v107, v107
    v_mov_b32_dpp v228, v224 row_newbcast:7 row_mask:0xf bank_mask:0xf
    v_mov_b32_dpp v229, v225 row_newbcast:7 row_mask:0xf bank_mask:0xf
    v_fma_f32 v104, v104, v228, v229
    v_fma_f32 v105, v105, v228, v229
    v_fma_f32 v106, v106, v228, v229
    v_fma_f32 v107, v107, v228, v229
    v_cvt_pk_bf16_f32 v215, v100, v104
    v_cvt_pk_bf16_f32 v219, v101, v105
    v_cvt_pk_bf16_f32 v79, v102, v106
    v_cvt_pk_bf16_f32 v83, v103, v107
    buffer_store_dwordx4 v[212:215], v4, s[28:31], s68 offen sc1
    buffer_store_dwordx4 v[216:219], v5, s[28:31], s68 offen sc1
    buffer_store_dwordx4 v[76:79], v6, s[28:31], s68 offen sc1
    buffer_store_dwordx4 v[80:83], v7, s[28:31], s68 offen sc1
    buffer_store_dwordx4 v[124:127], v243, s[28:31], s94 offen sc1
    buffer_store_dwordx4 v[132:135], v248, s[28:31], s94 offen sc1
    s_mov_b32 s71, 0
    s_cmp_eq_u32 s100, 3
    s_cselect_b32 s86, 5, 64
    s_lshl_b32 s76, s100, 8
    s_add_u32 s76, s76, 0x10100
    v_lshl_add_u32 v242, v0, 2, s76
    v_and_b32 v243, 3, v0
    v_lshlrev_b32 v243, 8, v243
    v_lshl_add_u32 v243, v0, 2, v243
    v_add_u32 v243, 0x10100, v243
    v_mov_b32 v240, 0
    s_waitcnt lgkmcnt(0)
L_main:
    s_waitcnt vmcnt(20)
    v_mfma_f32_16x16x32_bf16 v[44:47], a[128:131], a[0:3], v[12:15]
    v_mfma_f32_16x16x32_bf16 v[48:51], a[128:131], a[32:35], v[16:19]
    v_mfma_f32_16x16x32_bf16 v[52:55], a[128:131], a[64:67], v[20:23]
    v_mfma_f32_16x16x32_bf16 v[56:59], a[128:131], a[96:99], v[24:27]
    buffer_load_dwordx4 a[128:131], off, s[8:11], s69 offset:0 sc1
    v_mfma_f32_16x16x32_bf16 v[44:47], a[132:135], a[4:7], v[44:47]
    v_mfma_f32_16x16x32_bf16 v[48:51], a[132:135], a[36:39], v[48:51]
    v_mfma_f32_16x16x32_bf16 v[52:55], a[132:135], a[68:71], v[52:55]
    v_mfma_f32_16x16x32_bf16 v[56:59], a[132:135], a[100:103], v[56:59]
    s_waitcnt vmcnt(19)
    buffer_load_dwordx4 a[132:135], off, s[8:11], s69 offset:1024 sc1
    v_mfma_f32_16x16x32_bf16 v[44:47], a[136:139], a[8:11], v[44:47]
    v_mfma_f32_16x16x32_bf16 v[48:51], a[136:139], a[40:43], v[48:51]
    v_mfma_f32_16x16x32_bf16 v[52:55], a[136:139], a[72:75], v[52:55]
    v_mfma_f32_16x16x32_bf16 v[56:59], a[136:139], a[104:107], v[56:59]
    buffer_load_dwordx4 a[136:139], off, s[8:11], s69 offset:2048 sc1
    v_mfma_f32_16x16x32_bf16 v[44:47], a[140:143], a[12:15], v[44:47]
    v_mfma_f32_16x16x32_bf16 v[48:51], a[140:143], a[44:47], v[48:51]
    v_mfma_f32_16x16x32_bf16 v[52:55], a[140:143], a[76:79], v[52:55]
    v_mfma_f32_16x16x32_bf16 v[56:59], a[140:143], a[108:111], v[56:59]
    s_waitcnt vmcnt(19)
    buffer_load_dwordx4 a[140:143], off, s[8:11], s69 offset:3072 sc1
    v_mfma_f32_16x16x32_bf16 v[44:47], a[144:147], a[16:19], v[44:47]
    v_mfma_f32_16x16x32_bf16 v[48:51], a[144:147], a[48:51], v[48:51]
    v_mfma_f32_16x16x32_bf16 v[52:55], a[144:147], a[80:83], v[52:55]
    v_mfma_f32_16x16x32_bf16 v[56:59], a[144:147], a[112:115], v[56:59]
    buffer_load_dwordx4 a[144:147], off, s[12:15], s69 offset:0 sc1
    v_mfma_f32_16x16x32_bf16 v[44:47], a[148:151], a[20:23], v[44:47]
    v_mfma_f32_16x16x32_bf16 v[48:51], a[148:151], a[52:55], v[48:51]
    v_mfma_f32_16x16x32_bf16 v[52:55], a[148:151], a[84:87], v[52:55]
    v_mfma_f32_16x16x32_bf16 v[56:59], a[148:151], a[116:119], v[56:59]
    s_waitcnt vmcnt(19)
    buffer_load_dwordx4 a[148:151], off, s[12:15], s69 offset:1024 sc1
    v_mfma_f32_16x16x32_bf16 v[44:47], a[152:155], a[24:27], v[44:47]
    v_mfma_f32_16x16x32_bf16 v[48:51], a[152:155], a[56:59], v[48:51]
    v_mfma_f32_16x16x32_bf16 v[52:55], a[152:155], a[88:91], v[52:55]
    v_mfma_f32_16x16x32_bf16 v[56:59], a[152:155], a[120:123], v[56:59]
    buffer_load_dwordx4 a[152:155], off, s[12:15], s69 offset:2048 sc1
    v_mfma_f32_16x16x32_bf16 v[44:47], a[156:159], a[28:31], v[44:47]
    v_mfma_f32_16x16x32_bf16 v[48:51], a[156:159], a[60:63], v[48:51]
    v_mfma_f32_16x16x32_bf16 v[52:55], a[156:159], a[92:95], v[52:55]
    v_mfma_f32_16x16x32_bf16 v[56:59], a[156:159], a[124:127], v[56:59]
    s_waitcnt vmcnt(19)
    buffer_load_dwordx4 a[156:159], off, s[12:15], s69 offset:3072 sc1
    v_mfma_f32_16x16x32_bf16 v[60:63], a[160:163], a[0:3], v[12:15]
    v_mfma_f32_16x16x32_bf16 v[64:67], a[160:163], a[32:35], v[16:19]
    v_mfma_f32_16x16x32_bf16 v[68:71], a[160:163], a[64:67], v[20:23]
    v_mfma_f32_16x16x32_bf16 v[72:75], a[160:163], a[96:99], v[24:27]
    buffer_load_dwordx4 a[160:163], off, s[16:19], s69 offset:0 sc1
    v_mfma_f32_16x16x32_bf16 v[60:63], a[164:167], a[4:7], v[60:63]
    v_mfma_f32_16x16x32_bf16 v[64:67], a[164:167], a[36:39], v[64:67]
    v_exp_f32 v44, v44
    v_mfma_f32_16x16x32_bf16 v[68:71], a[164:167], a[68:71], v[68:71]
    v_exp_f32 v45, v45
    v_mfma_f32_16x16x32_bf16 v[72:75], a[164:167], a[100:103], v[72:75]
    s_waitcnt vmcnt(19)
    buffer_load_dwordx4 a[164:167], off, s[16:19], s69 offset:1024 sc1
    v_mfma_f32_16x16x32_bf16 v[60:63], a[168:171], a[8:11], v[60:63]
    v_exp_f32 v46, v46
    v_mfma_f32_16x16x32_bf16 v[64:67], a[168:171], a[40:43], v[64:67]
    v_exp_f32 v47, v47
    v_mfma_f32_16x16x32_bf16 v[68:71], a[168:171], a[72:75], v[68:71]
    v_cvt_pk_bf16_f32 v44, v44, v45
    v_cvt_pk_bf16_f32 v45, v46, v47
    v_mfma_f32_16x16x32_bf16 v[72:75], a[168:171], a[104:107], v[72:75]
    buffer_load_dwordx4 a[168:171], off, s[16:19], s69 offset:2048 sc1
    v_mfma_f32_16x16x32_bf16 v[60:63], a[172:175], a[12:15], v[60:63]
    v_exp_f32 v48, v48
    v_mfma_f32_16x16x32_bf16 v[64:67], a[172:175], a[44:47], v[64:67]
    v_exp_f32 v49, v49
    v_mfma_f32_16x16x32_bf16 v[68:71], a[172:175], a[76:79], v[68:71]
    v_exp_f32 v50, v50
    v_mfma_f32_16x16x32_bf16 v[72:75], a[172:175], a[108:111], v[72:75]
    s_waitcnt vmcnt(19)
    buffer_load_dwordx4 a[172:175], off, s[16:19], s69 offset:3072 sc1
    v_mfma_f32_16x16x32_bf16 v[60:63], a[176:179], a[16:19], v[60:63]
    v_exp_f32 v51, v51
    v_mfma_f32_16x16x32_bf16 v[64:67], a[176:179], a[48:51], v[64:67]
    v_cvt_pk_bf16_f32 v48, v48, v49
    v_cvt_pk_bf16_f32 v49, v50, v51
    v_mfma_f32_16x16x32_bf16 v[68:71], a[176:179], a[80:83], v[68:71]
    v_exp_f32 v52, v52
    v_mfma_f32_16x16x32_bf16 v[72:75], a[176:179], a[112:115], v[72:75]
    buffer_load_dwordx4 a[176:179], off, s[20:23], s69 offset:0 sc1
    v_mfma_f32_16x16x32_bf16 v[60:63], a[180:183], a[20:23], v[60:63]
    v_exp_f32 v53, v53
    v_mfma_f32_16x16x32_bf16 v[64:67], a[180:183], a[52:55], v[64:67]
    v_exp_f32 v54, v54
    v_mfma_f32_16x16x32_bf16 v[68:71], a[180:183], a[84:87], v[68:71]
    v_exp_f32 v55, v55
    v_mfma_f32_16x16x32_bf16 v[72:75], a[180:183], a[116:119], v[72:75]
    s_waitcnt vmcnt(19)
    buffer_load_dwordx4 a[180:183], off, s[20:23], s69 offset:1024 sc1
    v_mfma_f32_16x16x32_bf16 v[60:63], a[184:187], a[24:27], v[60:63]
    v_cvt_pk_bf16_f32 v52, v52, v53
    v_cvt_pk_bf16_f32 v53, v54, v55
    v_mfma_f32_16x16x32_bf16 v[64:67], a[184:187], a[56:59], v[64:67]
    v_exp_f32 v56, v56
    v_mfma_f32_16x16x32_bf16 v[68:71], a[184:187], a[88:91], v[68:71]
    v_exp_f32 v57, v57
    v_mfma_f32_16x16x32_bf16 v[72:75], a[184:187], a[120:123], v[72:75]
    buffer_load_dwordx4 a[184:187], off, s[20:23], s69 offset:2048 sc1
    v_mfma_f32_16x16x32_bf16 v[60:63], a[188:191], a[28:31], v[60:63]
    v_exp_f32 v58, v58
    v_mfma_f32_16x16x32_bf16 v[64:67], a[188:191], a[60:63], v[64:67]
    v_exp_f32 v59, v59
    v_mfma_f32_16x16x32_bf16 v[68:71], a[188:191], a[92:95], v[68:71]
    v_cvt_pk_bf16_f32 v56, v56, v57
    v_cvt_pk_bf16_f32 v57, v58, v59
    v_mfma_f32_16x16x32_bf16 v[72:75], a[188:191], a[124:127], v[72:75]
    buffer_load_dwordx4 a[188:191], off, s[20:23], s69 offset:3072 sc1
    s_lshr_b64 s[92:93], s[92:93], 4
    s_and_b32 s69, s92, 15
    s_lshl_b32 s69, s69, 17
    s_nop 0
    v_exp_f32 v60, v60
    v_exp_f32 v61, v61
    v_exp_f32 v62, v62
    v_exp_f32 v63, v63
    s_nop 0
    v_cvt_pk_bf16_f32 v46, v60, v61
    v_cvt_pk_bf16_f32 v47, v62, v63
    v_exp_f32 v64, v64
    v_exp_f32 v65, v65
    v_exp_f32 v66, v66
    v_exp_f32 v67, v67
    ds_write_b128 v2, v[44:47] offset:0
    v_mfma_f32_16x16x32_bf16 v[28:31], v[8:11], v[44:47], v[28:31]
    v_cvt_pk_bf16_f32 v50, v64, v65
    v_cvt_pk_bf16_f32 v51, v66, v67
    v_exp_f32 v68, v68
    v_exp_f32 v69, v69
    v_exp_f32 v70, v70
    v_exp_f32 v71, v71
    ds_write_b128 v2, v[48:51] offset:1024
    v_mfma_f32_16x16x32_bf16 v[32:35], v[8:11], v[48:51], v[32:35]
    v_cvt_pk_bf16_f32 v54, v68, v69
    v_cvt_pk_bf16_f32 v55, v70, v71
    v_exp_f32 v72, v72
    v_exp_f32 v73, v73
    v_exp_f32 v74, v74
    v_exp_f32 v75, v75
    ds_write_b128 v2, v[52:55] offset:2048
    v_mfma_f32_16x16x32_bf16 v[36:39], v[8:11], v[52:55], v[36:39]
    v_cvt_pk_bf16_f32 v58, v72, v73
    v_cvt_pk_bf16_f32 v59, v74, v75
    ds_write_b128 v2, v[56:59] offset:3072
    s_nop 0
    v_mfma_f32_16x16x32_bf16 v[40:43], v[8:11], v[56:59], v[40:43]
    buffer_load_dwordx4 a[192:195], off, s[8:11], s70 offset:0 sc1
    buffer_load_dwordx4 a[208:211], off, s[8:11], s70 offset:1024 sc1
    buffer_load_dwordx4 a[224:227], off, s[8:11], s70 offset:2048 sc1
    buffer_load_dwordx4 a[240:243], off, s[8:11], s70 offset:3072 sc1
    buffer_load_dwordx4 a[196:199], off, s[12:15], s70 offset:0 sc1
    buffer_load_dwordx4 a[212:215], off, s[12:15], s70 offset:1024 sc1
    buffer_load_dwordx4 a[228:231], off, s[12:15], s70 offset:2048 sc1
    buffer_load_dwordx4 a[244:247], off, s[12:15], s70 offset:3072 sc1
    buffer_load_dwordx4 a[200:203], off, s[16:19], s70 offset:0 sc1
    buffer_load_dwordx4 a[216:219], off, s[16:19], s70 offset:1024 sc1
    buffer_load_dwordx4 a[232:235], off, s[16:19], s70 offset:2048 sc1
    s_mov_b32 s68, 7
    s_waitcnt vmcnt(19) lgkmcnt(0)
    s_barrier
    ds_read_b32 v241, v243
    s_cmp_eq_u32 s86, 64
    s_cbranch_scc1 L_no_pub
    buffer_store_dwordx2 v[254:255], v3, s[32:35], 0 offen offset:2048 sc1
L_no_pub:
.p2align 6
L_loop:
    v_mfma_f32_16x16x32_bf16 v[44:47], a[128:131], a[0:3], v[12:15]
    s_waitcnt lgkmcnt(0)
    v_cmp_gt_u32 vcc, v240, v241
    v_add_u32 v240, 1, v240
    v_mfma_f32_16x16x32_bf16 v[44:47], a[132:135], a[4:7], v[44:47]
    v_mfma_f32_16x16x32_bf16 v[44:47], a[136:139], a[8:11], v[44:47]
    s_cbranch_vccnz L_pw0
L_pw0_back:
    ds_read_b128 v[76:79], v1 offset:0
    ds_read_b128 v[92:95], v1 offset:4096
    v_mfma_f32_16x16x32_bf16 v[44:47], a[140:143], a[12:15], v[44:47]
    buffer_load_dwordx4 a[248:251], off, s[16:19], s70 offset:3072 sc1
    v_mfma_f32_16x16x32_bf16 v[44:47], a[144:147], a[16:19], v[44:47]
    ds_read_b128 v[108:111], v1 offset:8192
    ds_read_b128 v[124:127], v1 offset:12288
    v_mfma_f32_16x16x32_bf16 v[44:47], a[148:151], a[20:23], v[44:47]
    ds_read_b128 v[80:83], v1 offset:1024
    ds_read_b128 v[96:99], v1 offset:5120
    v_mfma_f32_16x16x32_bf16 v[44:47], a[152:155], a[24:27], v[44:47]
    ds_read_b128 v[112:115], v1 offset:9216
    ds_read_b128 v[128:131], v1 offset:13312
    v_mfma_f32_16x16x32_bf16 v[44:47], a[156:159], a[28:31], v[44:47]
    buffer_load_dwordx4 a[204:207], off, s[20:23], s70 offset:0 sc1
    v_mfma_f32_16x16x32_bf16 v[48:51], a[128:131], a[32:35], v[16:19]
    ds_read_b128 v[84:87], v1 offset:2048
    ds_read_b128 v[100:103], v1 offset:6144
    v_mfma_f32_16x16x32_bf16 v[48:51], a[132:135], a[36:39], v[48:51]
    ds_read_b128 v[116:119], v1 offset:10240
    ds_read_b128 v[132:135], v1 offset:14336
    v_mfma_f32_16x16x32_bf16 v[48:51], a[136:139], a[40:43], v[48:51]
    ds_read_b128 v[88:91], v1 offset:3072
    ds_read_b128 v[104:107], v1 offset:7168
    v_mfma_f32_16x16x32_bf16 v[48:51], a[140:143], a[44:47], v[48:51]
    buffer_load_dwordx4 a[220:223], off, s[20:23], s70 offset:1024 sc1
    v_mfma_f32_16x16x32_bf16 v[48:51], a[144:147], a[48:51], v[48:51]
    ds_read_b128 v[120:123], v1 offset:11264
    ds_read_b128 v[136:139], v1 offset:15360
    v_mfma_f32_16x16x32_bf16 v[48:51], a[148:151], a[52:55], v[48:51]
    v_mfma_f32_16x16x32_bf16 v[48:51], a[152:155], a[56:59], v[48:51]
    v_mfma_f32_16x16x32_bf16 v[48:51], a[156:159], a[60:63], v[48:51]
    buffer_load_dwordx4 a[236:239], off, s[20:23], s70 offset:2048 sc1
    v_mfma_f32_16x16x32_bf16 v[52:55], a[128:131], a[64:67], v[20:23]
    v_exp_f32 v44, v44
    v_mfma_f32_16x16x32_bf16 v[52:55], a[132:135], a[68:71], v[52:55]
    v_exp_f32 v45, v45
    v_mfma_f32_16x16x32_bf16 v[52:55], a[136:139], a[72:75], v[52:55]
    v_exp_f32 v46, v46
    v_mfma_f32_16x16x32_bf16 v[52:55], a[140:143], a[76:79], v[52:55]
    buffer_load_dwordx4 a[252:255], off, s[20:23], s70 offset:3072 sc1
    v_mfma_f32_16x16x32_bf16 v[52:55], a[144:147], a[80:83], v[52:55]
    s_lshr_b64 s[96:97], s[96:97], 4
    v_exp_f32 v47, v47
    v_mfma_f32_16x16x32_bf16 v[52:55], a[148:151], a[84:87], v[52:55]
    s_and_b32 s70, s96, 15
    v_cvt_pk_bf16_f32 v44, v44, v45
    v_cvt_pk_bf16_f32 v45, v46, v47
    v_mfma_f32_16x16x32_bf16 v[52:55], a[152:155], a[88:91], v[52:55]
    s_lshl_b32 s70, s70, 17
    s_or_b32 s70, s70, 0x4000
    v_mfma_f32_16x16x32_bf16 v[52:55], a[156:159], a[92:95], v[52:55]
    v_exp_f32 v48, v48
    v_mfma_f32_16x16x32_bf16 v[56:59], a[128:131], a[96:99], v[24:27]
    buffer_load_dwordx4 a[128:131], off, s[8:11], s69 offset:0 sc1
    v_mfma_f32_16x16x32_bf16 v[56:59], a[132:135], a[100:103], v[56:59]
    v_exp_f32 v49, v49
    v_mfma_f32_16x16x32_bf16 v[56:59], a[136:139], a[104:107], v[56:59]
    v_exp_f32 v50, v50
    v_mfma_f32_16x16x32_bf16 v[56:59], a[140:143], a[108:111], v[56:59]
    v_exp_f32 v51, v51
    v_mfma_f32_16x16x32_bf16 v[56:59], a[144:147], a[112:115], v[56:59]
    buffer_load_dwordx4 a[132:135], off, s[8:11], s69 offset:1024 sc1
    v_mfma_f32_16x16x32_bf16 v[56:59], a[148:151], a[116:119], v[56:59]
    v_cvt_pk_bf16_f32 v48, v48, v49
    v_cvt_pk_bf16_f32 v49, v50, v51
    v_mfma_f32_16x16x32_bf16 v[56:59], a[152:155], a[120:123], v[56:59]
    v_mfma_f32_16x16x32_bf16 v[56:59], a[156:159], a[124:127], v[56:59]
    s_waitcnt vmcnt(18)
    v_exp_f32 v52, v52
    v_mfma_f32_16x16x32_bf16 v[60:63], a[160:163], a[0:3], v[12:15]
    buffer_load_dwordx4 a[136:139], off, s[8:11], s69 offset:2048 sc1
    v_mfma_f32_16x16x32_bf16 v[60:63], a[164:167], a[4:7], v[60:63]
    v_exp_f32 v53, v53
    v_mfma_f32_16x16x32_bf16 v[60:63], a[168:171], a[8:11], v[60:63]
    v_exp_f32 v54, v54
    v_mfma_f32_16x16x32_bf16 v[60:63], a[172:175], a[12:15], v[60:63]
    v_exp_f32 v55, v55
    v_mfma_f32_16x16x32_bf16 v[60:63], a[176:179], a[16:19], v[60:63]
    buffer_load_dwordx4 a[140:143], off, s[8:11], s69 offset:3072 sc1
    v_mfma_f32_16x16x32_bf16 v[60:63], a[180:183], a[20:23], v[60:63]
    v_cvt_pk_bf16_f32 v52, v52, v53
    v_cvt_pk_bf16_f32 v53, v54, v55
    v_mfma_f32_16x16x32_bf16 v[60:63], a[184:187], a[24:27], v[60:63]
    v_mfma_f32_16x16x32_bf16 v[60:63], a[188:191], a[28:31], v[60:63]
    v_exp_f32 v56, v56
    v_mfma_f32_16x16x32_bf16 v[64:67], a[160:163], a[32:35], v[16:19]
    buffer_load_dwordx4 a[144:147], off, s[12:15], s69 offset:0 sc1
    v_mfma_f32_16x16x32_bf16 v[64:67], a[164:167], a[36:39], v[64:67]
    v_exp_f32 v57, v57
    v_mfma_f32_16x16x32_bf16 v[64:67], a[168:171], a[40:43], v[64:67]
    v_exp_f32 v58, v58
    v_mfma_f32_16x16x32_bf16 v[64:67], a[172:175], a[44:47], v[64:67]
    v_exp_f32 v59, v59
    v_mfma_f32_16x16x32_bf16 v[64:67], a[176:179], a[48:51], v[64:67]
    buffer_load_dwordx4 a[148:151], off, s[12:15], s69 offset:1024 sc1
    v_mfma_f32_16x16x32_bf16 v[64:67], a[180:183], a[52:55], v[64:67]
    v_cvt_pk_bf16_f32 v56, v56, v57
    v_cvt_pk_bf16_f32 v57, v58, v59
    v_mfma_f32_16x16x32_bf16 v[64:67], a[184:187], a[56:59], v[64:67]
    v_mfma_f32_16x16x32_bf16 v[64:67], a[188:191], a[60:63], v[64:67]
    v_exp_f32 v60, v60
    v_mfma_f32_16x16x32_bf16 v[68:71], a[160:163], a[64:67], v[20:23]
    buffer_load_dwordx4 a[152:155], off, s[12:15], s69 offset:2048 sc1
    v_mfma_f32_16x16x32_bf16 v[68:71], a[164:167], a[68:71], v[68:71]
    v_exp_f32 v61, v61
    v_mfma_f32_16x16x32_bf16 v[68:71], a[168:171], a[72:75], v[68:71]
    v_exp_f32 v62, v62
    v_mfma_f32_16x16x32_bf16 v[68:71], a[172:175], a[76:79], v[68:71]
    v_exp_f32 v63, v63
    v_mfma_f32_16x16x32_bf16 v[68:71], a[176:179], a[80:83], v[68:71]
    buffer_load_dwordx4 a[156:159], off, s[12:15], s69 offset:3072 sc1
    v_mfma_f32_16x16x32_bf16 v[68:71], a[180:183], a[84:87], v[68:71]
    v_cvt_pk_bf16_f32 v46, v60, v61
    v_cvt_pk_bf16_f32 v47, v62, v63
    v_mfma_f32_16x16x32_bf16 v[68:71], a[184:187], a[88:91], v[68:71]
    ds_write_b128 v2, v[44:47] offset:16384
    v_mfma_f32_16x16x32_bf16 v[68:71], a[188:191], a[92:95], v[68:71]
    v_exp_f32 v64, v64
    v_mfma_f32_16x16x32_bf16 v[72:75], a[160:163], a[96:99], v[24:27]
    buffer_load_dwordx4 a[160:163], off, s[16:19], s69 offset:0 sc1
    v_mfma_f32_16x16x32_bf16 v[72:75], a[164:167], a[100:103], v[72:75]
    v_exp_f32 v65, v65
    v_mfma_f32_16x16x32_bf16 v[72:75], a[168:171], a[104:107], v[72:75]
    v_exp_f32 v66, v66
    v_mfma_f32_16x16x32_bf16 v[72:75], a[172:175], a[108:111], v[72:75]
    v_exp_f32 v67, v67
    v_mfma_f32_16x16x32_bf16 v[72:75], a[176:179], a[112:115], v[72:75]
    buffer_load_dwordx4 a[164:167], off, s[16:19], s69 offset:1024 sc1
    v_mfma_f32_16x16x32_bf16 v[72:75], a[180:183], a[116:119], v[72:75]
    v_cvt_pk_bf16_f32 v50, v64, v65
    v_cvt_pk_bf16_f32 v51, v66, v67
    v_mfma_f32_16x16x32_bf16 v[72:75], a[184:187], a[120:123], v[72:75]
    ds_write_b128 v2, v[48:51] offset:17408
    v_mfma_f32_16x16x32_bf16 v[72:75], a[188:191], a[124:127], v[72:75]
    s_waitcnt vmcnt(22) lgkmcnt(2)
    v_exp_f32 v68, v68
    v_mfma_f32_16x16x32_bf16 v[140:143], v[76:79], a[192:195], v[140:143]
    buffer_load_dwordx4 a[168:171], off, s[16:19], s69 offset:2048 sc1
    v_mfma_f32_16x16x32_bf16 v[140:143], v[92:95], a[208:211], v[140:143]
    v_exp_f32 v69, v69
    v_mfma_f32_16x16x32_bf16 v[140:143], v[108:111], a[224:227], v[140:143]
    v_exp_f32 v70, v70
    v_mfma_f32_16x16x32_bf16 v[140:143], v[124:127], a[240:243], v[140:143]
    v_exp_f32 v71, v71
    v_mfma_f32_16x16x32_bf16 v[144:147], v[80:83], a[192:195], v[144:147]
    buffer_load_dwordx4 a[172:175], off, s[16:19], s69 offset:3072 sc1
    v_mfma_f32_16x16x32_bf16 v[144:147], v[96:99], a[208:211], v[144:147]
    v_cvt_pk_bf16_f32 v54, v68, v69
    v_cvt_pk_bf16_f32 v55, v70, v71
    v_mfma_f32_16x16x32_bf16 v[144:147], v[112:115], a[224:227], v[144:147]
    ds_write_b128 v2, v[52:55] offset:18432
    v_mfma_f32_16x16x32_bf16 v[144:147], v[128:131], a[240:243], v[144:147]
    v_exp_f32 v72, v72
    v_mfma_f32_16x16x32_bf16 v[148:151], v[84:87], a[192:195], v[148:151]
    buffer_load_dwordx4 a[176:179], off, s[20:23], s69 offset:0 sc1
    v_mfma_f32_16x16x32_bf16 v[148:151], v[100:103], a[208:211], v[148:151]
    v_exp_f32 v73, v73
    v_mfma_f32_16x16x32_bf16 v[148:151], v[116:119], a[224:227], v[148:151]
    v_exp_f32 v74, v74
    v_mfma_f32_16x16x32_bf16 v[148:151], v[132:135], a[240:243], v[148:151]
    v_exp_f32 v75, v75
    v_mfma_f32_16x16x32_bf16 v[152:155], v[88:91], a[192:195], v[152:155]
    buffer_load_dwordx4 a[180:183], off, s[20:23], s69 offset:1024 sc1
    v_mfma_f32_16x16x32_bf16 v[152:155], v[104:107], a[208:211], v[152:155]
    v_cvt_pk_bf16_f32 v58, v72, v73
    v_cvt_pk_bf16_f32 v59, v74, v75
    v_mfma_f32_16x16x32_bf16 v[152:155], v[120:123], a[224:227], v[152:155]
    ds_write_b128 v2, v[56:59] offset:19456
    v_mfma_f32_16x16x32_bf16 v[152:155], v[136:139], a[240:243], v[152:155]
    s_waitcnt vmcnt(22)
    v_mfma_f32_16x16x32_bf16 v[156:159], v[76:79], a[196:199], v[156:159]
    buffer_load_dwordx4 a[184:187], off, s[20:23], s69 offset:2048 sc1
    v_mfma_f32_16x16x32_bf16 v[156:159], v[92:95], a[212:215], v[156:159]
    ds_write_b32 v242, v240
    v_mfma_f32_16x16x32_bf16 v[156:159], v[108:111], a[228:231], v[156:159]
    v_mfma_f32_16x16x32_bf16 v[156:159], v[124:127], a[244:247], v[156:159]
    v_mfma_f32_16x16x32_bf16 v[160:163], v[80:83], a[196:199], v[160:163]
    buffer_load_dwordx4 a[188:191], off, s[20:23], s69 offset:3072 sc1
    v_mfma_f32_16x16x32_bf16 v[160:163], v[96:99], a[212:215], v[160:163]
    s_lshr_b64 s[92:93], s[92:93], 4
    s_and_b32 s69, s92, 15
    v_mfma_f32_16x16x32_bf16 v[160:163], v[112:115], a[228:231], v[160:163]
    s_lshl_b32 s69, s69, 17
    v_mfma_f32_16x16x32_bf16 v[160:163], v[128:131], a[244:247], v[160:163]
    v_mfma_f32_16x16x32_bf16 v[28:31], v[8:11], v[44:47], v[28:31]
    buffer_load_dwordx4 a[192:195], off, s[8:11], s70 offset:0 sc1
    v_mfma_f32_16x16x32_bf16 v[164:167], v[84:87], a[196:199], v[164:167]
    v_mfma_f32_16x16x32_bf16 v[164:167], v[100:103], a[212:215], v[164:167]
    v_mfma_f32_16x16x32_bf16 v[164:167], v[116:119], a[228:231], v[164:167]
    v_mfma_f32_16x16x32_bf16 v[164:167], v[132:135], a[244:247], v[164:167]
    buffer_load_dwordx4 a[208:211], off, s[8:11], s70 offset:1024 sc1
    v_mfma_f32_16x16x32_bf16 v[168:171], v[88:91], a[196:199], v[168:171]
    v_mfma_f32_16x16x32_bf16 v[168:171], v[104:107], a[212:215], v[168:171]
    v_mfma_f32_16x16x32_bf16 v[168:171], v[120:123], a[228:231], v[168:171]
    v_mfma_f32_16x16x32_bf16 v[168:171], v[136:139], a[244:247], v[168:171]
    buffer_load_dwordx4 a[224:227], off, s[8:11], s70 offset:2048 sc1
    v_mfma_f32_16x16x32_bf16 v[32:35], v[8:11], v[48:51], v[32:35]
    s_waitcnt vmcnt(23)
    v_mfma_f32_16x16x32_bf16 v[172:175], v[76:79], a[200:203], v[172:175]
    v_mfma_f32_16x16x32_bf16 v[172:175], v[92:95], a[216:219], v[172:175]
    v_mfma_f32_16x16x32_bf16 v[172:175], v[108:111], a[232:235], v[172:175]
    buffer_load_dwordx4 a[240:243], off, s[8:11], s70 offset:3072 sc1
    v_mfma_f32_16x16x32_bf16 v[172:175], v[124:127], a[248:251], v[172:175]
    v_mfma_f32_16x16x32_bf16 v[176:179], v[80:83], a[200:203], v[176:179]
    v_mfma_f32_16x16x32_bf16 v[176:179], v[96:99], a[216:219], v[176:179]
    v_mfma_f32_16x16x32_bf16 v[176:179], v[112:115], a[232:235], v[176:179]
    buffer_load_dwordx4 a[196:199], off, s[12:15], s70 offset:0 sc1
    v_mfma_f32_16x16x32_bf16 v[176:179], v[128:131], a[248:251], v[176:179]
    v_mfma_f32_16x16x32_bf16 v[36:39], v[8:11], v[52:55], v[36:39]
    v_mfma_f32_16x16x32_bf16 v[180:183], v[84:87], a[200:203], v[180:183]
    v_mfma_f32_16x16x32_bf16 v[180:183], v[100:103], a[216:219], v[180:183]
    buffer_load_dwordx4 a[212:215], off, s[12:15], s70 offset:1024 sc1
    v_mfma_f32_16x16x32_bf16 v[180:183], v[116:119], a[232:235], v[180:183]
    v_mfma_f32_16x16x32_bf16 v[180:183], v[132:135], a[248:251], v[180:183]
    v_mfma_f32_16x16x32_bf16 v[184:187], v[88:91], a[200:203], v[184:187]
    v_mfma_f32_16x16x32_bf16 v[184:187], v[104:107], a[216:219], v[184:187]
    buffer_load_dwordx4 a[228:231], off, s[12:15], s70 offset:2048 sc1
    v_mfma_f32_16x16x32_bf16 v[184:187], v[120:123], a[232:235], v[184:187]
    v_mfma_f32_16x16x32_bf16 v[184:187], v[136:139], a[248:251], v[184:187]
    v_mfma_f32_16x16x32_bf16 v[40:43], v[8:11], v[56:59], v[40:43]
    s_waitcnt vmcnt(23)
    v_mfma_f32_16x16x32_bf16 v[188:191], v[76:79], a[204:207], v[188:191]
    buffer_load_dwordx4 a[244:247], off, s[12:15], s70 offset:3072 sc1
    v_mfma_f32_16x16x32_bf16 v[188:191], v[92:95], a[220:223], v[188:191]
    v_mfma_f32_16x16x32_bf16 v[188:191], v[108:111], a[236:239], v[188:191]
    v_mfma_f32_16x16x32_bf16 v[188:191], v[124:127], a[252:255], v[188:191]
    v_mfma_f32_16x16x32_bf16 v[192:195], v[80:83], a[204:207], v[192:195]
    buffer_load_dwordx4 a[200:203], off, s[16:19], s70 offset:0 sc1
    v_mfma_f32_16x16x32_bf16 v[192:195], v[96:99], a[220:223], v[192:195]
    v_mfma_f32_16x16x32_bf16 v[192:195], v[112:115], a[236:239], v[192:195]
    v_mfma_f32_16x16x32_bf16 v[192:195], v[128:131], a[252:255], v[192:195]
    v_mfma_f32_16x16x32_bf16 v[196:199], v[84:87], a[204:207], v[196:199]
    buffer_load_dwordx4 a[216:219], off, s[16:19], s70 offset:1024 sc1
    v_mfma_f32_16x16x32_bf16 v[196:199], v[100:103], a[220:223], v[196:199]
    v_mfma_f32_16x16x32_bf16 v[196:199], v[116:119], a[236:239], v[196:199]
    ds_read_b32 v241, v243
    v_mfma_f32_16x16x32_bf16 v[196:199], v[132:135], a[252:255], v[196:199]
    v_mfma_f32_16x16x32_bf16 v[200:203], v[88:91], a[204:207], v[200:203]
    buffer_load_dwordx4 a[232:235], off, s[16:19], s70 offset:2048 sc1
    v_mfma_f32_16x16x32_bf16 v[200:203], v[104:107], a[220:223], v[200:203]
    v_mfma_f32_16x16x32_bf16 v[200:203], v[120:123], a[236:239], v[200:203]
    v_mfma_f32_16x16x32_bf16 v[200:203], v[136:139], a[252:255], v[200:203]
    s_waitcnt vmcnt(19)
    v_mfma_f32_16x16x32_bf16 v[44:47], a[128:131], a[0:3], v[12:15]
    s_waitcnt lgkmcnt(0)
    v_cmp_gt_u32 vcc, v240, v241
    v_add_u32 v240, 1, v240
    v_mfma_f32_16x16x32_bf16 v[44:47], a[132:135], a[4:7], v[44:47]
    v_mfma_f32_16x16x32_bf16 v[44:47], a[136:139], a[8:11], v[44:47]
    s_cbranch_vccnz L_pw1
L_pw1_back:
    ds_read_b128 v[76:79], v1 offset:16384
    ds_read_b128 v[92:95], v1 offset:20480
    v_mfma_f32_16x16x32_bf16 v[44:47], a[140:143], a[12:15], v[44:47]
    buffer_load_dwordx4 a[248:251], off, s[16:19], s70 offset:3072 sc1
    v_mfma_f32_16x16x32_bf16 v[44:47], a[144:147], a[16:19], v[44:47]
    ds_read_b128 v[108:111], v1 offset:24576
    ds_read_b128 v[124:127], v1 offset:28672
    v_mfma_f32_16x16x32_bf16 v[44:47], a[148:151], a[20:23], v[44:47]
    ds_read_b128 v[80:83], v1 offset:17408
    ds_read_b128 v[96:99], v1 offset:21504
    v_mfma_f32_16x16x32_bf16 v[44:47], a[152:155], a[24:27], v[44:47]
    ds_read_b128 v[112:115], v1 offset:25600
    ds_read_b128 v[128:131], v1 offset:29696
    v_mfma_f32_16x16x32_bf16 v[44:47], a[156:159], a[28:31], v[44:47]
    buffer_load_dwordx4 a[204:207], off, s[20:23], s70 offset:0 sc1
    v_mfma_f32_16x16x32_bf16 v[48:51], a[128:131], a[32:35], v[16:19]
    ds_read_b128 v[84:87], v1 offset:18432
    ds_read_b128 v[100:103], v1 offset:22528
    v_mfma_f32_16x16x32_bf16 v[48:51], a[132:135], a[36:39], v[48:51]
    ds_read_b128 v[116:119], v1 offset:26624
    ds_read_b128 v[132:135], v1 offset:30720
    v_mfma_f32_16x16x32_bf16 v[48:51], a[136:139], a[40:43], v[48:51]
    ds_read_b128 v[88:91], v1 offset:19456
    ds_read_b128 v[104:107], v1 offset:23552
    v_mfma_f32_16x16x32_bf16 v[48:51], a[140:143], a[44:47], v[48:51]
    buffer_load_dwordx4 a[220:223], off, s[20:23], s70 offset:1024 sc1
    v_mfma_f32_16x16x32_bf16 v[48:51], a[144:147], a[48:51], v[48:51]
    ds_read_b128 v[120:123], v1 offset:27648
    ds_read_b128 v[136:139], v1 offset:31744
    v_mfma_f32_16x16x32_bf16 v[48:51], a[148:151], a[52:55], v[48:51]
    v_mfma_f32_16x16x32_bf16 v[48:51], a[152:155], a[56:59], v[48:51]
    v_mfma_f32_16x16x32_bf16 v[48:51], a[156:159], a[60:63], v[48:51]
    buffer_load_dwordx4 a[236:239], off, s[20:23], s70 offset:2048 sc1
    v_mfma_f32_16x16x32_bf16 v[52:55], a[128:131], a[64:67], v[20:23]
    v_exp_f32 v44, v44
    v_mfma_f32_16x16x32_bf16 v[52:55], a[132:135], a[68:71], v[52:55]
    v_exp_f32 v45, v45
    v_mfma_f32_16x16x32_bf16 v[52:55], a[136:139], a[72:75], v[52:55]
    v_exp_f32 v46, v46
    v_mfma_f32_16x16x32_bf16 v[52:55], a[140:143], a[76:79], v[52:55]
    buffer_load_dwordx4 a[252:255], off, s[20:23], s70 offset:3072 sc1
    v_mfma_f32_16x16x32_bf16 v[52:55], a[144:147], a[80:83], v[52:55]
    s_lshr_b64 s[96:97], s[96:97], 4
    v_exp_f32 v47, v47
    v_mfma_f32_16x16x32_bf16 v[52:55], a[148:151], a[84:87], v[52:55]
    s_and_b32 s70, s96, 15
    v_cvt_pk_bf16_f32 v44, v44, v45
    v_cvt_pk_bf16_f32 v45, v46, v47
    v_mfma_f32_16x16x32_bf16 v[52:55], a[152:155], a[88:91], v[52:55]
    s_lshl_b32 s70, s70, 17
    s_or_b32 s70, s70, 0x4000
    v_mfma_f32_16x16x32_bf16 v[52:55], a[156:159], a[92:95], v[52:55]
    v_exp_f32 v48, v48
    v_mfma_f32_16x16x32_bf16 v[56:59], a[128:131], a[96:99], v[24:27]
    buffer_load_dwordx4 a[128:131], off, s[8:11], s69 offset:0 sc1
    v_mfma_f32_16x16x32_bf16 v[56:59], a[132:135], a[100:103], v[56:59]
    v_exp_f32 v49, v49
    v_mfma_f32_16x16x32_bf16 v[56:59], a[136:139], a[104:107], v[56:59]
    v_exp_f32 v50, v50
    v_mfma_f32_16x16x32_bf16 v[56:59], a[140:143], a[108:111], v[56:59]
    v_exp_f32 v51, v51
    v_mfma_f32_16x16x32_bf16 v[56:59], a[144:147], a[112:115], v[56:59]
    buffer_load_dwordx4 a[132:135], off, s[8:11], s69 offset:1024 sc1
    v_mfma_f32_16x16x32_bf16 v[56:59], a[148:151], a[116:119], v[56:59]
    v_cvt_pk_bf16_f32 v48, v48, v49
    v_cvt_pk_bf16_f32 v49, v50, v51
    v_mfma_f32_16x16x32_bf16 v[56:59], a[152:155], a[120:123], v[56:59]
    v_mfma_f32_16x16x32_bf16 v[56:59], a[156:159], a[124:127], v[56:59]
    s_waitcnt vmcnt(18)
    v_exp_f32 v52, v52
    v_mfma_f32_16x16x32_bf16 v[60:63], a[160:163], a[0:3], v[12:15]
    buffer_load_dwordx4 a[136:139], off, s[8:11], s69 offset:2048 sc1
    v_mfma_f32_16x16x32_bf16 v[60:63], a[164:167], a[4:7], v[60:63]
    v_exp_f32 v53, v53
    v_mfma_f32_16x16x32_bf16 v[60:63], a[168:171], a[8:11], v[60:63]
    v_exp_f32 v54, v54
    v_mfma_f32_16x16x32_bf16 v[60:63], a[172:175], a[12:15], v[60:63]
    v_exp_f32 v55, v55
    v_mfma_f32_16x16x32_bf16 v[60:63], a[176:179], a[16:19], v[60:63]
    buffer_load_dwordx4 a[140:143], off, s[8:11], s69 offset:3072 sc1
    v_mfma_f32_16x16x32_bf16 v[60:63], a[180:183], a[20:23], v[60:63]
    v_cvt_pk_bf16_f32 v52, v52, v53
    v_cvt_pk_bf16_f32 v53, v54, v55
    v_mfma_f32_16x16x32_bf16 v[60:63], a[184:187], a[24:27], v[60:63]
    v_mfma_f32_16x16x32_bf16 v[60:63], a[188:191], a[28:31], v[60:63]
    v_exp_f32 v56, v56
    v_mfma_f32_16x16x32_bf16 v[64:67], a[160:163], a[32:35], v[16:19]
    buffer_load_dwordx4 a[144:147], off, s[12:15], s69 offset:0 sc1
    v_mfma_f32_16x16x32_bf16 v[64:67], a[164:167], a[36:39], v[64:67]
    v_exp_f32 v57, v57
    v_mfma_f32_16x16x32_bf16 v[64:67], a[168:171], a[40:43], v[64:67]
    v_exp_f32 v58, v58
    v_mfma_f32_16x16x32_bf16 v[64:67], a[172:175], a[44:47], v[64:67]
    v_exp_f32 v59, v59
    v_mfma_f32_16x16x32_bf16 v[64:67], a[176:179], a[48:51], v[64:67]
    buffer_load_dwordx4 a[148:151], off, s[12:15], s69 offset:1024 sc1
    v_mfma_f32_16x16x32_bf16 v[64:67], a[180:183], a[52:55], v[64:67]
    v_cvt_pk_bf16_f32 v56, v56, v57
    v_cvt_pk_bf16_f32 v57, v58, v59
    v_mfma_f32_16x16x32_bf16 v[64:67], a[184:187], a[56:59], v[64:67]
    v_mfma_f32_16x16x32_bf16 v[64:67], a[188:191], a[60:63], v[64:67]
    v_exp_f32 v60, v60
    v_mfma_f32_16x16x32_bf16 v[68:71], a[160:163], a[64:67], v[20:23]
    buffer_load_dwordx4 a[152:155], off, s[12:15], s69 offset:2048 sc1
    v_mfma_f32_16x16x32_bf16 v[68:71], a[164:167], a[68:71], v[68:71]
    v_exp_f32 v61, v61
    v_mfma_f32_16x16x32_bf16 v[68:71], a[168:171], a[72:75], v[68:71]
    v_exp_f32 v62, v62
    v_mfma_f32_16x16x32_bf16 v[68:71], a[172:175], a[76:79], v[68:71]
    v_exp_f32 v63, v63
    v_mfma_f32_16x16x32_bf16 v[68:71], a[176:179], a[80:83], v[68:71]
    buffer_load_dwordx4 a[156:159], off, s[12:15], s69 offset:3072 sc1
    v_mfma_f32_16x16x32_bf16 v[68:71], a[180:183], a[84:87], v[68:71]
    v_cvt_pk_bf16_f32 v46, v60, v61
    v_cvt_pk_bf16_f32 v47, v62, v63
    v_mfma_f32_16x16x32_bf16 v[68:71], a[184:187], a[88:91], v[68:71]
    ds_write_b128 v2, v[44:47] offset:0
    v_mfma_f32_16x16x32_bf16 v[68:71], a[188:191], a[92:95], v[68:71]
    v_exp_f32 v64, v64
    v_mfma_f32_16x16x32_bf16 v[72:75], a[160:163], a[96:99], v[24:27]
    buffer_load_dwordx4 a[160:163], off, s[16:19], s69 offset:0 sc1
    v_mfma_f32_16x16x32_bf16 v[72:75], a[164:167], a[100:103], v[72:75]
    v_exp_f32 v65, v65
    v_mfma_f32_16x16x32_bf16 v[72:75], a[168:171], a[104:107], v[72:75]
    v_exp_f32 v66, v66
    v_mfma_f32_16x16x32_bf16 v[72:75], a[172:175], a[108:111], v[72:75]
    v_exp_f32 v67, v67
    v_mfma_f32_16x16x32_bf16 v[72:75], a[176:179], a[112:115], v[72:75]
    buffer_load_dwordx4 a[164:167], off, s[16:19], s69 offset:1024 sc1
    v_mfma_f32_16x16x32_bf16 v[72:75], a[180:183], a[116:119], v[72:75]
    v_cvt_pk_bf16_f32 v50, v64, v65
    v_cvt_pk_bf16_f32 v51, v66, v67
    v_mfma_f32_16x16x32_bf16 v[72:75], a[184:187], a[120:123], v[72:75]
    ds_write_b128 v2, v[48:51] offset:1024
    v_mfma_f32_16x16x32_bf16 v[72:75], a[188:191], a[124:127], v[72:75]
    s_waitcnt vmcnt(22) lgkmcnt(2)
    v_exp_f32 v68, v68
    v_mfma_f32_16x16x32_bf16 v[140:143], v[76:79], a[192:195], v[140:143]
    buffer_load_dwordx4 a[168:171], off, s[16:19], s69 offset:2048 sc1
    v_mfma_f32_16x16x32_bf16 v[140:143], v[92:95], a[208:211], v[140:143]
    v_exp_f32 v69, v69
    v_mfma_f32_16x16x32_bf16 v[140:143], v[108:111], a[224:227], v[140:143]
    v_exp_f32 v70, v70
    v_mfma_f32_16x16x32_bf16 v[140:143], v[124:127], a[240:243], v[140:143]
    v_exp_f32 v71, v71
    v_mfma_f32_16x16x32_bf16 v[144:147], v[80:83], a[192:195], v[144:147]
    buffer_load_dwordx4 a[172:175], off, s[16:19], s69 offset:3072 sc1
    v_mfma_f32_16x16x32_bf16 v[144:147], v[96:99], a[208:211], v[144:147]
    v_cvt_pk_bf16_f32 v54, v68, v69
    v_cvt_pk_bf16_f32 v55, v70, v71
    v_mfma_f32_16x16x32_bf16 v[144:147], v[112:115], a[224:227], v[144:147]
    ds_write_b128 v2, v[52:55] offset:2048
    v_mfma_f32_16x16x32_bf16 v[144:147], v[128:131], a[240:243], v[144:147]
    v_exp_f32 v72, v72
    v_mfma_f32_16x16x32_bf16 v[148:151], v[84:87], a[192:195], v[148:151]
    buffer_load_dwordx4 a[176:179], off, s[20:23], s69 offset:0 sc1
    v_mfma_f32_16x16x32_bf16 v[148:151], v[100:103], a[208:211], v[148:151]
    v_exp_f32 v73, v73
    v_mfma_f32_16x16x32_bf16 v[148:151], v[116:119], a[224:227], v[148:151]
    v_exp_f32 v74, v74
    v_mfma_f32_16x16x32_bf16 v[148:151], v[132:135], a[240:243], v[148:151]
    v_exp_f32 v75, v75
    v_mfma_f32_16x16x32_bf16 v[152:155], v[88:91], a[192:195], v[152:155]
    buffer_load_dwordx4 a[180:183], off, s[20:23], s69 offset:1024 sc1
    v_mfma_f32_16x16x32_bf16 v[152:155], v[104:107], a[208:211], v[152:155]
    v_cvt_pk_bf16_f32 v58, v72, v73
    v_cvt_pk_bf16_f32 v59, v74, v75
    v_mfma_f32_16x16x32_bf16 v[152:155], v[120:123], a[224:227], v[152:155]
    ds_write_b128 v2, v[56:59] offset:3072
    v_mfma_f32_16x16x32_bf16 v[152:155], v[136:139], a[240:243], v[152:155]
    s_waitcnt vmcnt(22)
    v_mfma_f32_16x16x32_bf16 v[156:159], v[76:79], a[196:199], v[156:159]
    buffer_load_dwordx4 a[184:187], off, s[20:23], s69 offset:2048 sc1
    v_mfma_f32_16x16x32_bf16 v[156:159], v[92:95], a[212:215], v[156:159]
    s_cmp_ge_u32 s68, s86
    s_cbranch_scc1 L_event
L_event_back:
L_check_back:
    ds_write_b32 v242, v240
    v_mfma_f32_16x16x32_bf16 v[156:159], v[108:111], a[228:231], v[156:159]
    v_mfma_f32_16x16x32_bf16 v[156:159], v[124:127], a[244:247], v[156:159]
    v_mfma_f32_16x16x32_bf16 v[160:163], v[80:83], a[196:199], v[160:163]
    buffer_load_dwordx4 a[188:191], off, s[20:23], s69 offset:3072 sc1
    v_mfma_f32_16x16x32_bf16 v[160:163], v[96:99], a[212:215], v[160:163]
    s_lshr_b64 s[92:93], s[92:93], 4
    s_and_b32 s69, s92, 15
    v_mfma_f32_16x16x32_bf16 v[160:163], v[112:115], a[228:231], v[160:163]
    s_lshl_b32 s69, s69, 17
    v_mfma_f32_16x16x32_bf16 v[160:163], v[128:131], a[244:247], v[160:163]
    v_mfma_f32_16x16x32_bf16 v[28:31], v[8:11], v[44:47], v[28:31]
    buffer_load_dwordx4 a[192:195], off, s[8:11], s70 offset:0 sc1
    v_mfma_f32_16x16x32_bf16 v[164:167], v[84:87], a[196:199], v[164:167]
    v_mfma_f32_16x16x32_bf16 v[164:167], v[100:103], a[212:215], v[164:167]
    v_mfma_f32_16x16x32_bf16 v[164:167], v[116:119], a[228:231], v[164:167]
    v_mfma_f32_16x16x32_bf16 v[164:167], v[132:135], a[244:247], v[164:167]
    buffer_load_dwordx4 a[208:211], off, s[8:11], s70 offset:1024 sc1
    v_mfma_f32_16x16x32_bf16 v[168:171], v[88:91], a[196:199], v[168:171]
    v_mfma_f32_16x16x32_bf16 v[168:171], v[104:107], a[212:215], v[168:171]
    v_mfma_f32_16x16x32_bf16 v[168:171], v[120:123], a[228:231], v[168:171]
    v_mfma_f32_16x16x32_bf16 v[168:171], v[136:139], a[244:247], v[168:171]
    buffer_load_dwordx4 a[224:227], off, s[8:11], s70 offset:2048 sc1
    v_mfma_f32_16x16x32_bf16 v[32:35], v[8:11], v[48:51], v[32:35]
    s_waitcnt vmcnt(23)
    v_mfma_f32_16x16x32_bf16 v[172:175], v[76:79], a[200:203], v[172:175]
    v_mfma_f32_16x16x32_bf16 v[172:175], v[92:95], a[216:219], v[172:175]
    v_mfma_f32_16x16x32_bf16 v[172:175], v[108:111], a[232:235], v[172:175]
    buffer_load_dwordx4 a[240:243], off, s[8:11], s70 offset:3072 sc1
    v_mfma_f32_16x16x32_bf16 v[172:175], v[124:127], a[248:251], v[172:175]
    v_mfma_f32_16x16x32_bf16 v[176:179], v[80:83], a[200:203], v[176:179]
    v_mfma_f32_16x16x32_bf16 v[176:179], v[96:99], a[216:219], v[176:179]
    v_mfma_f32_16x16x32_bf16 v[176:179], v[112:115], a[232:235], v[176:179]
    buffer_load_dwordx4 a[196:199], off, s[12:15], s70 offset:0 sc1
    v_mfma_f32_16x16x32_bf16 v[176:179], v[128:131], a[248:251], v[176:179]
    v_mfma_f32_16x16x32_bf16 v[36:39], v[8:11], v[52:55], v[36:39]
    v_mfma_f32_16x16x32_bf16 v[180:183], v[84:87], a[200:203], v[180:183]
    v_mfma_f32_16x16x32_bf16 v[180:183], v[100:103], a[216:219], v[180:183]
    buffer_load_dwordx4 a[212:215], off, s[12:15], s70 offset:1024 sc1
    v_mfma_f32_16x16x32_bf16 v[180:183], v[116:119], a[232:235], v[180:183]
    v_mfma_f32_16x16x32_bf16 v[180:183], v[132:135], a[248:251], v[180:183]
    v_mfma_f32_16x16x32_bf16 v[184:187], v[88:91], a[200:203], v[184:187]
    v_mfma_f32_16x16x32_bf16 v[184:187], v[104:107], a[216:219], v[184:187]
    buffer_load_dwordx4 a[228:231], off, s[12:15], s70 offset:2048 sc1
    v_mfma_f32_16x16x32_bf16 v[184:187], v[120:123], a[232:235], v[184:187]
    v_mfma_f32_16x16x32_bf16 v[184:187], v[136:139], a[248:251], v[184:187]
    v_mfma_f32_16x16x32_bf16 v[40:43], v[8:11], v[56:59], v[40:43]
    s_waitcnt vmcnt(23)
    v_mfma_f32_16x16x32_bf16 v[188:191], v[76:79], a[204:207], v[188:191]
    buffer_load_dwordx4 a[244:247], off, s[12:15], s70 offset:3072 sc1
    v_mfma_f32_16x16x32_bf16 v[188:191], v[92:95], a[220:223], v[188:191]
    v_mfma_f32_16x16x32_bf16 v[188:191], v[108:111], a[236:239], v[188:191]
    v_mfma_f32_16x16x32_bf16 v[188:191], v[124:127], a[252:255], v[188:191]
    v_mfma_f32_16x16x32_bf16 v[192:195], v[80:83], a[204:207], v[192:195]
    buffer_load_dwordx4 a[200:203], off, s[16:19], s70 offset:0 sc1
    v_mfma_f32_16x16x32_bf16 v[192:195], v[96:99], a[220:223], v[192:195]
    v_mfma_f32_16x16x32_bf16 v[192:195], v[112:115], a[236:239], v[192:195]
    v_mfma_f32_16x16x32_bf16 v[192:195], v[128:131], a[252:255], v[192:195]
    v_mfma_f32_16x16x32_bf16 v[196:199], v[84:87], a[204:207], v[196:199]
    buffer_load_dwordx4 a[216:219], off, s[16:19], s70 offset:1024 sc1
    v_mfma_f32_16x16x32_bf16 v[196:199], v[100:103], a[220:223], v[196:199]
    v_mfma_f32_16x16x32_bf16 v[196:199], v[116:119], a[236:239], v[196:199]
    ds_read_b32 v241, v243
    v_mfma_f32_16x16x32_bf16 v[196:199], v[132:135], a[252:255], v[196:199]
    v_mfma_f32_16x16x32_bf16 v[200:203], v[88:91], a[204:207], v[200:203]
    buffer_load_dwordx4 a[232:235], off, s[16:19], s70 offset:2048 sc1
    v_mfma_f32_16x16x32_bf16 v[200:203], v[104:107], a[220:223], v[200:203]
    v_mfma_f32_16x16x32_bf16 v[200:203], v[120:123], a[236:239], v[200:203]
    v_mfma_f32_16x16x32_bf16 v[200:203], v[136:139], a[252:255], v[200:203]
    s_waitcnt vmcnt(19)
    s_sub_u32 s68, s68, 1
    s_cmp_lg_u32 s68, 0
    s_cbranch_scc1 L_loop
L_tail:
    v_mfma_f32_16x16x32_bf16 v[44:47], a[128:131], a[0:3], v[12:15]
    s_waitcnt lgkmcnt(0)
    v_cmp_gt_u32 vcc, v240, v241
    v_add_u32 v240, 1, v240
    v_mfma_f32_16x16x32_bf16 v[44:47], a[132:135], a[4:7], v[44:47]
    v_mfma_f32_16x16x32_bf16 v[44:47], a[136:139], a[8:11], v[44:47]
    s_cbranch_vccnz L_pw14
L_pw14_back:
    ds_read_b128 v[76:79], v1 offset:0
    ds_read_b128 v[92:95], v1 offset:4096
    v_mfma_f32_16x16x32_bf16 v[44:47], a[140:143], a[12:15], v[44:47]
    buffer_load_dwordx4 a[248:251], off, s[16:19], s70 offset:3072 sc1
    v_mfma_f32_16x16x32_bf16 v[44:47], a[144:147], a[16:19], v[44:47]
    ds_read_b128 v[108:111], v1 offset:8192
    ds_read_b128 v[124:127], v1 offset:12288
    v_mfma_f32_16x16x32_bf16 v[44:47], a[148:151], a[20:23], v[44:47]
    ds_read_b128 v[80:83], v1 offset:1024
    ds_read_b128 v[96:99], v1 offset:5120
    v_mfma_f32_16x16x32_bf16 v[44:47], a[152:155], a[24:27], v[44:47]
    ds_read_b128 v[112:115], v1 offset:9216
    ds_read_b128 v[128:131], v1 offset:13312
    v_mfma_f32_16x16x32_bf16 v[44:47], a[156:159], a[28:31], v[44:47]
    buffer_load_dwordx4 a[204:207], off, s[20:23], s70 offset:0 sc1
    v_mfma_f32_16x16x32_bf16 v[48:51], a[128:131], a[32:35], v[16:19]
    ds_read_b128 v[84:87], v1 offset:2048
    ds_read_b128 v[100:103], v1 offset:6144
    v_mfma_f32_16x16x32_bf16 v[48:51], a[132:135], a[36:39], v[48:51]
    ds_read_b128 v[116:119], v1 offset:10240
    ds_read_b128 v[132:135], v1 offset:14336
    v_mfma_f32_16x16x32_bf16 v[48:51], a[136:139], a[40:43], v[48:51]
    ds_read_b128 v[88:91], v1 offset:3072
    ds_read_b128 v[104:107], v1 offset:7168
    v_mfma_f32_16x16x32_bf16 v[48:51], a[140:143], a[44:47], v[48:51]
    buffer_load_dwordx4 a[220:223], off, s[20:23], s70 offset:1024 sc1
    v_mfma_f32_16x16x32_bf16 v[48:51], a[144:147], a[48:51], v[48:51]
    ds_read_b128 v[120:123], v1 offset:11264
    ds_read_b128 v[136:139], v1 offset:15360
    v_mfma_f32_16x16x32_bf16 v[48:51], a[148:151], a[52:55], v[48:51]
    v_mfma_f32_16x16x32_bf16 v[48:51], a[152:155], a[56:59], v[48:51]
    v_mfma_f32_16x16x32_bf16 v[48:51], a[156:159], a[60:63], v[48:51]
    buffer_load_dwordx4 a[236:239], off, s[20:23], s70 offset:2048 sc1
    v_mfma_f32_16x16x32_bf16 v[52:55], a[128:131], a[64:67], v[20:23]
    v_exp_f32 v44, v44
    v_mfma_f32_16x16x32_bf16 v[52:55], a[132:135], a[68:71], v[52:55]
    v_exp_f32 v45, v45
    v_mfma_f32_16x16x32_bf16 v[52:55], a[136:139], a[72:75], v[52:55]
    v_exp_f32 v46, v46
    v_mfma_f32_16x16x32_bf16 v[52:55], a[140:143], a[76:79], v[52:55]
    buffer_load_dwordx4 a[252:255], off, s[20:23], s70 offset:3072 sc1
    v_mfma_f32_16x16x32_bf16 v[52:55], a[144:147], a[80:83], v[52:55]
    s_lshr_b64 s[96:97], s[96:97], 4
    v_exp_f32 v47, v47
    v_mfma_f32_16x16x32_bf16 v[52:55], a[148:151], a[84:87], v[52:55]
    s_and_b32 s70, s96, 15
    v_cvt_pk_bf16_f32 v44, v44, v45
    v_cvt_pk_bf16_f32 v45, v46, v47
    v_mfma_f32_16x16x32_bf16 v[52:55], a[152:155], a[88:91], v[52:55]
    s_lshl_b32 s70, s70, 17
    s_or_b32 s70, s70, 0x4000
    v_mfma_f32_16x16x32_bf16 v[52:55], a[156:159], a[92:95], v[52:55]
    v_exp_f32 v48, v48
    v_mfma_f32_16x16x32_bf16 v[56:59], a[128:131], a[96:99], v[24:27]
    buffer_load_dwordx4 a[128:131], off, s[8:11], s70 offset:0 sc1
    v_mfma_f32_16x16x32_bf16 v[56:59], a[132:135], a[100:103], v[56:59]
    v_exp_f32 v49, v49
    v_mfma_f32_16x16x32_bf16 v[56:59], a[136:139], a[104:107], v[56:59]
    v_exp_f32 v50, v50
    v_mfma_f32_16x16x32_bf16 v[56:59], a[140:143], a[108:111], v[56:59]
    v_exp_f32 v51, v51
    v_mfma_f32_16x16x32_bf16 v[56:59], a[144:147], a[112:115], v[56:59]
    buffer_load_dwordx4 a[144:147], off, s[8:11], s70 offset:1024 sc1
    v_mfma_f32_16x16x32_bf16 v[56:59], a[148:151], a[116:119], v[56:59]
    v_cvt_pk_bf16_f32 v48, v48, v49
    v_cvt_pk_bf16_f32 v49, v50, v51
    v_mfma_f32_16x16x32_bf16 v[56:59], a[152:155], a[120:123], v[56:59]
    v_mfma_f32_16x16x32_bf16 v[56:59], a[156:159], a[124:127], v[56:59]
    s_waitcnt vmcnt(18)
    v_exp_f32 v52, v52
    v_mfma_f32_16x16x32_bf16 v[60:63], a[160:163], a[0:3], v[12:15]
    buffer_load_dwordx4 a[132:135], off, s[12:15], s70 offset:0 sc1
    v_mfma_f32_16x16x32_bf16 v[60:63], a[164:167], a[4:7], v[60:63]
    v_exp_f32 v53, v53
    v_mfma_f32_16x16x32_bf16 v[60:63], a[168:171], a[8:11], v[60:63]
    v_exp_f32 v54, v54
    v_mfma_f32_16x16x32_bf16 v[60:63], a[172:175], a[12:15], v[60:63]
    v_exp_f32 v55, v55
    v_mfma_f32_16x16x32_bf16 v[60:63], a[176:179], a[16:19], v[60:63]
    buffer_load_dwordx4 a[148:151], off, s[12:15], s70 offset:1024 sc1
    v_mfma_f32_16x16x32_bf16 v[60:63], a[180:183], a[20:23], v[60:63]
    v_cvt_pk_bf16_f32 v52, v52, v53
    v_cvt_pk_bf16_f32 v53, v54, v55
    v_mfma_f32_16x16x32_bf16 v[60:63], a[184:187], a[24:27], v[60:63]
    v_mfma_f32_16x16x32_bf16 v[60:63], a[188:191], a[28:31], v[60:63]
    v_exp_f32 v56, v56
    v_mfma_f32_16x16x32_bf16 v[64:67], a[160:163], a[32:35], v[16:19]
    buffer_load_dwordx4 a[136:139], off, s[16:19], s70 offset:0 sc1
    v_mfma_f32_16x16x32_bf16 v[64:67], a[164:167], a[36:39], v[64:67]
    v_exp_f32 v57, v57
    v_mfma_f32_16x16x32_bf16 v[64:67], a[168:171], a[40:43], v[64:67]
    v_exp_f32 v58, v58
    v_mfma_f32_16x16x32_bf16 v[64:67], a[172:175], a[44:47], v[64:67]
    v_exp_f32 v59, v59
    v_mfma_f32_16x16x32_bf16 v[64:67], a[176:179], a[48:51], v[64:67]
    buffer_load_dwordx4 a[152:155], off, s[16:19], s70 offset:1024 sc1
    v_mfma_f32_16x16x32_bf16 v[64:67], a[180:183], a[52:55], v[64:67]
    v_cvt_pk_bf16_f32 v56, v56, v57
    v_cvt_pk_bf16_f32 v57, v58, v59
    v_mfma_f32_16x16x32_bf16 v[64:67], a[184:187], a[56:59], v[64:67]
    v_mfma_f32_16x16x32_bf16 v[64:67], a[188:191], a[60:63], v[64:67]
    v_exp_f32 v60, v60
    v_mfma_f32_16x16x32_bf16 v[68:71], a[160:163], a[64:67], v[20:23]
    buffer_load_dwordx4 a[140:143], off, s[20:23], s70 offset:0 sc1
    v_mfma_f32_16x16x32_bf16 v[68:71], a[164:167], a[68:71], v[68:71]
    v_exp_f32 v61, v61
    v_mfma_f32_16x16x32_bf16 v[68:71], a[168:171], a[72:75], v[68:71]
    v_exp_f32 v62, v62
    v_mfma_f32_16x16x32_bf16 v[68:71], a[172:175], a[76:79], v[68:71]
    v_exp_f32 v63, v63
    v_mfma_f32_16x16x32_bf16 v[68:71], a[176:179], a[80:83], v[68:71]
    buffer_load_dwordx4 a[156:159], off, s[20:23], s70 offset:1024 sc1
    v_mfma_f32_16x16x32_bf16 v[68:71], a[180:183], a[84:87], v[68:71]
    v_cvt_pk_bf16_f32 v46, v60, v61
    v_cvt_pk_bf16_f32 v47, v62, v63
    v_mfma_f32_16x16x32_bf16 v[68:71], a[184:187], a[88:91], v[68:71]
    ds_write_b128 v2, v[44:47] offset:16384
    v_mfma_f32_16x16x32_bf16 v[68:71], a[188:191], a[92:95], v[68:71]
    v_exp_f32 v64, v64
    v_mfma_f32_16x16x32_bf16 v[72:75], a[160:163], a[96:99], v[24:27]
    buffer_load_dwordx4 a[160:163], off, s[8:11], s70 offset:2048 sc1
    v_mfma_f32_16x16x32_bf16 v[72:75], a[164:167], a[100:103], v[72:75]
    v_exp_f32 v65, v65
    v_mfma_f32_16x16x32_bf16 v[72:75], a[168:171], a[104:107], v[72:75]
    v_exp_f32 v66, v66
    v_mfma_f32_16x16x32_bf16 v[72:75], a[172:175], a[108:111], v[72:75]
    v_exp_f32 v67, v67
    v_mfma_f32_16x16x32_bf16 v[72:75], a[176:179], a[112:115], v[72:75]
    buffer_load_dwordx4 a[176:179], off, s[8:11], s70 offset:3072 sc1
    v_mfma_f32_16x16x32_bf16 v[72:75], a[180:183], a[116:119], v[72:75]
    v_cvt_pk_bf16_f32 v50, v64, v65
    v_cvt_pk_bf16_f32 v51, v66, v67
    v_mfma_f32_16x16x32_bf16 v[72:75], a[184:187], a[120:123], v[72:75]
    ds_write_b128 v2, v[48:51] offset:17408
    v_mfma_f32_16x16x32_bf16 v[72:75], a[188:191], a[124:127], v[72:75]
    v_exp_f32 v68, v68
    v_mfma_f32_16x16x32_bf16 v[28:31], v[8:11], v[44:47], v[28:31]
    buffer_load_dwordx4 a[164:167], off, s[12:15], s70 offset:2048 sc1
    v_mfma_f32_16x16x32_bf16 v[32:35], v[8:11], v[48:51], v[32:35]
    s_waitcnt vmcnt(11) lgkmcnt(2)
    v_exp_f32 v69, v69
    v_mfma_f32_16x16x32_bf16 v[140:143], v[76:79], a[192:195], v[140:143]
    v_exp_f32 v70, v70
    v_mfma_f32_16x16x32_bf16 v[140:143], v[92:95], a[208:211], v[140:143]
    v_exp_f32 v71, v71
    v_mfma_f32_16x16x32_bf16 v[140:143], v[108:111], a[224:227], v[140:143]
    buffer_load_dwordx4 a[180:183], off, s[12:15], s70 offset:3072 sc1
    v_mfma_f32_16x16x32_bf16 v[140:143], v[124:127], a[240:243], v[140:143]
    v_cvt_pk_bf16_f32 v54, v68, v69
    v_cvt_pk_bf16_f32 v55, v70, v71
    v_mfma_f32_16x16x32_bf16 v[156:159], v[76:79], a[196:199], v[156:159]
    ds_write_b128 v2, v[52:55] offset:18432
    v_mfma_f32_16x16x32_bf16 v[156:159], v[92:95], a[212:215], v[156:159]
    v_exp_f32 v72, v72
    v_mfma_f32_16x16x32_bf16 v[156:159], v[108:111], a[228:231], v[156:159]
    buffer_load_dwordx4 a[168:171], off, s[16:19], s70 offset:2048 sc1
    v_mfma_f32_16x16x32_bf16 v[156:159], v[124:127], a[244:247], v[156:159]
    v_exp_f32 v73, v73
    v_mfma_f32_16x16x32_bf16 v[172:175], v[76:79], a[200:203], v[172:175]
    v_exp_f32 v74, v74
    v_mfma_f32_16x16x32_bf16 v[172:175], v[92:95], a[216:219], v[172:175]
    v_exp_f32 v75, v75
    v_mfma_f32_16x16x32_bf16 v[172:175], v[108:111], a[232:235], v[172:175]
    buffer_load_dwordx4 a[184:187], off, s[16:19], s70 offset:3072 sc1
    v_mfma_f32_16x16x32_bf16 v[172:175], v[124:127], a[248:251], v[172:175]
    v_cvt_pk_bf16_f32 v58, v72, v73
    v_cvt_pk_bf16_f32 v59, v74, v75
    v_mfma_f32_16x16x32_bf16 v[188:191], v[76:79], a[204:207], v[188:191]
    ds_write_b128 v2, v[56:59] offset:19456
    v_mfma_f32_16x16x32_bf16 v[188:191], v[92:95], a[220:223], v[188:191]
    ds_write_b32 v242, v240
    v_mfma_f32_16x16x32_bf16 v[188:191], v[108:111], a[236:239], v[188:191]
    buffer_load_dwordx4 a[172:175], off, s[20:23], s70 offset:2048 sc1
    v_mfma_f32_16x16x32_bf16 v[188:191], v[124:127], a[252:255], v[188:191]
    v_mfma_f32_16x16x32_bf16 v[36:39], v[8:11], v[52:55], v[36:39]
    v_mfma_f32_16x16x32_bf16 v[40:43], v[8:11], v[56:59], v[40:43]
    v_mfma_f32_16x16x32_bf16 v[144:147], v[80:83], a[192:195], v[144:147]
    buffer_load_dwordx4 a[188:191], off, s[20:23], s70 offset:3072 sc1
    v_mfma_f32_16x16x32_bf16 v[144:147], v[96:99], a[208:211], v[144:147]
    v_mfma_f32_16x16x32_bf16 v[144:147], v[112:115], a[224:227], v[144:147]
    v_mfma_f32_16x16x32_bf16 v[144:147], v[128:131], a[240:243], v[144:147]
    v_mfma_f32_16x16x32_bf16 v[160:163], v[80:83], a[196:199], v[160:163]
    v_mfma_f32_16x16x32_bf16 v[160:163], v[96:99], a[212:215], v[160:163]
    v_mfma_f32_16x16x32_bf16 v[160:163], v[112:115], a[228:231], v[160:163]
    v_mfma_f32_16x16x32_bf16 v[160:163], v[128:131], a[244:247], v[160:163]
    ds_write_b32 v247, v28 offset:32768
    ds_write_b32 v247, v32 offset:33024
    v_mfma_f32_16x16x32_bf16 v[176:179], v[80:83], a[200:203], v[176:179]
    ds_write_b32 v247, v36 offset:33280
    ds_write_b32 v247, v40 offset:33536
    v_mfma_f32_16x16x32_bf16 v[176:179], v[96:99], a[216:219], v[176:179]
    v_mfma_f32_16x16x32_bf16 v[176:179], v[112:115], a[232:235], v[176:179]
    v_mfma_f32_16x16x32_bf16 v[176:179], v[128:131], a[248:251], v[176:179]
    s_waitcnt lgkmcnt(0)
    s_barrier
    ds_read_b128 v[204:207], v246 offset:32768
    ds_read_b128 v[208:211], v246 offset:33024
    v_mfma_f32_16x16x32_bf16 v[192:195], v[80:83], a[204:207], v[192:195]
    ds_read_b128 v[212:215], v246 offset:33280
    ds_read_b128 v[216:219], v246 offset:33536
    v_mfma_f32_16x16x32_bf16 v[192:195], v[96:99], a[220:223], v[192:195]
    ds_read_b128 v[76:79], v1 offset:16384
    ds_read_b128 v[92:95], v1 offset:20480
    v_mfma_f32_16x16x32_bf16 v[192:195], v[112:115], a[236:239], v[192:195]
    ds_read_b128 v[108:111], v1 offset:24576
    ds_read_b128 v[124:127], v1 offset:28672
    v_mfma_f32_16x16x32_bf16 v[192:195], v[128:131], a[252:255], v[192:195]
    ds_read_b128 v[80:83], v1 offset:17408
    ds_read_b128 v[96:99], v1 offset:21504
    v_mfma_f32_16x16x32_bf16 v[148:151], v[84:87], a[192:195], v[148:151]
    ds_read_b128 v[112:115], v1 offset:25600
    ds_read_b128 v[128:131], v1 offset:29696
    v_mfma_f32_16x16x32_bf16 v[148:151], v[100:103], a[208:211], v[148:151]
    s_waitcnt lgkmcnt(0)
    v_add_f32 v204, v204, v205
    v_add_f32 v206, v206, v207
    v_mfma_f32_16x16x32_bf16 v[148:151], v[116:119], a[224:227], v[148:151]
    v_add_f32 v208, v208, v209
    v_add_f32 v210, v210, v211
    v_mfma_f32_16x16x32_bf16 v[148:151], v[132:135], a[240:243], v[148:151]
    v_add_f32 v212, v212, v213
    v_add_f32 v214, v214, v215
    v_mfma_f32_16x16x32_bf16 v[164:167], v[84:87], a[196:199], v[164:167]
    v_add_f32 v216, v216, v217
    v_add_f32 v218, v218, v219
    v_mfma_f32_16x16x32_bf16 v[164:167], v[100:103], a[212:215], v[164:167]
    v_add_f32 v204, v204, v206
    v_add_f32 v208, v208, v210
    v_mfma_f32_16x16x32_bf16 v[164:167], v[116:119], a[228:231], v[164:167]
    v_add_f32 v212, v212, v214
    v_add_f32 v216, v216, v218
    v_mfma_f32_16x16x32_bf16 v[164:167], v[132:135], a[244:247], v[164:167]
    v_rcp_f32 v207, v204
    v_mfma_f32_16x16x32_bf16 v[180:183], v[84:87], a[200:203], v[180:183]
    v_rcp_f32 v211, v208
    v_mfma_f32_16x16x32_bf16 v[180:183], v[100:103], a[216:219], v[180:183]
    v_rcp_f32 v215, v212
    v_mfma_f32_16x16x32_bf16 v[180:183], v[116:119], a[232:235], v[180:183]
    v_rcp_f32 v219, v216
    v_mfma_f32_16x16x32_bf16 v[180:183], v[132:135], a[248:251], v[180:183]
    ds_write_b32 v249, v207 offset:34816
    ds_write_b32 v249, v211 offset:34880
    v_mfma_f32_16x16x32_bf16 v[196:199], v[84:87], a[204:207], v[196:199]
    ds_write_b32 v249, v215 offset:34944
    ds_write_b32 v249, v219 offset:35008
    v_mfma_f32_16x16x32_bf16 v[196:199], v[100:103], a[220:223], v[196:199]
    ds_read_b128 v[220:223], v253 offset:34816
    ds_read_b128 v[224:227], v253 offset:34880
    v_mfma_f32_16x16x32_bf16 v[196:199], v[116:119], a[236:239], v[196:199]
    ds_read_b128 v[228:231], v253 offset:34944
    ds_read_b128 v[232:235], v253 offset:35008
    v_mfma_f32_16x16x32_bf16 v[196:199], v[132:135], a[252:255], v[196:199]
    s_waitcnt vmcnt(0)
    s_waitcnt lgkmcnt(0)
    ds_read_b128 v[84:87], v1 offset:18432
    ds_read_b128 v[100:103], v1 offset:22528
    v_mfma_f32_16x16x32_bf16 v[140:143], v[76:79], a[128:131], v[140:143]
    ds_read_b128 v[116:119], v1 offset:26624
    ds_read_b128 v[132:135], v1 offset:30720
    v_mfma_f32_16x16x32_bf16 v[140:143], v[92:95], a[144:147], v[140:143]
    v_min3_f32 v205, v204, v208, v212
    v_max3_f32 v206, v204, v208, v212
    v_mfma_f32_16x16x32_bf16 v[140:143], v[108:111], a[160:163], v[140:143]
    v_min_f32 v205, v205, v216
    v_max_f32 v206, v206, v216
    v_mfma_f32_16x16x32_bf16 v[140:143], v[124:127], a[176:179], v[140:143]
    v_cmp_gt_f32 vcc, 0x30800000, v205
    v_mov_b32 v209, 0x4e800000
    v_mfma_f32_16x16x32_bf16 v[156:159], v[76:79], a[132:135], v[156:159]
    v_cmp_lt_f32 s[78:79], v209, v206
    v_mfma_f32_16x16x32_bf16 v[156:159], v[92:95], a[148:151], v[156:159]
    v_mfma_f32_16x16x32_bf16 v[156:159], v[108:111], a[164:167], v[156:159]
    v_mfma_f32_16x16x32_bf16 v[156:159], v[124:127], a[180:183], v[156:159]
    s_or_b64 vcc, vcc, s[78:79]
    s_cselect_b32 s75, 1, 0
    v_mfma_f32_16x16x32_bf16 v[172:175], v[76:79], a[136:139], v[172:175]
    s_cmp_lt_u32 s71, s75
    s_cbranch_scc1 L_fallback
    v_mfma_f32_16x16x32_bf16 v[172:175], v[92:95], a[152:155], v[172:175]
    s_mov_b32 s76, 0
    v_mfma_f32_16x16x32_bf16 v[172:175], v[108:111], a[168:171], v[172:175]
    s_waitcnt lgkmcnt(0)
    v_mfma_f32_16x16x32_bf16 v[172:175], v[124:127], a[184:187], v[172:175]
    v_mfma_f32_16x16x32_bf16 v[188:191], v[76:79], a[140:143], v[188:191]
    v_mfma_f32_16x16x32_bf16 v[188:191], v[92:95], a[156:159], v[188:191]
    v_mfma_f32_16x16x32_bf16 v[188:191], v[108:111], a[172:175], v[188:191]
    v_mfma_f32_16x16x32_bf16 v[188:191], v[124:127], a[188:191], v[188:191]
    s_waitcnt lgkmcnt(0)
    ds_read_b128 v[76:79], v1 offset:19456
    ds_read_b128 v[92:95], v1 offset:23552
    v_mfma_f32_16x16x32_bf16 v[144:147], v[80:83], a[128:131], v[144:147]
    ds_read_b128 v[108:111], v1 offset:27648
    ds_read_b128 v[124:127], v1 offset:31744
    v_mfma_f32_16x16x32_bf16 v[144:147], v[96:99], a[144:147], v[144:147]
    v_mfma_f32_16x16x32_bf16 v[144:147], v[112:115], a[160:163], v[144:147]
    v_mfma_f32_16x16x32_bf16 v[144:147], v[128:131], a[176:179], v[144:147]
    v_mfma_f32_16x16x32_bf16 v[160:163], v[80:83], a[132:135], v[160:163]
    v_mfma_f32_16x16x32_bf16 v[160:163], v[96:99], a[148:151], v[160:163]
    v_mfma_f32_16x16x32_bf16 v[160:163], v[112:115], a[164:167], v[160:163]
    v_mfma_f32_16x16x32_bf16 v[160:163], v[128:131], a[180:183], v[160:163]
    v_mul_f32 v140, v140, v220
    v_mul_f32 v156, v156, v220
    v_mfma_f32_16x16x32_bf16 v[176:179], v[80:83], a[136:139], v[176:179]
    v_mul_f32 v172, v172, v220
    v_mul_f32 v188, v188, v220
    v_mfma_f32_16x16x32_bf16 v[176:179], v[96:99], a[152:155], v[176:179]
    v_cvt_pk_bf16_f32 v204, v140, v156
    v_cvt_pk_bf16_f32 v205, v172, v188
    v_mfma_f32_16x16x32_bf16 v[176:179], v[112:115], a[168:171], v[176:179]
    buffer_store_dwordx2 v[204:205], v251, s[36:39], s76 offen offset:0 sc0 sc1
    v_mfma_f32_16x16x32_bf16 v[176:179], v[128:131], a[184:187], v[176:179]
    v_mul_f32 v141, v141, v221
    v_mul_f32 v157, v157, v221
    v_mfma_f32_16x16x32_bf16 v[192:195], v[80:83], a[140:143], v[192:195]
    v_mul_f32 v173, v173, v221
    v_mul_f32 v189, v189, v221
    v_mfma_f32_16x16x32_bf16 v[192:195], v[96:99], a[156:159], v[192:195]
    v_cvt_pk_bf16_f32 v206, v141, v157
    v_cvt_pk_bf16_f32 v207, v173, v189
    v_mfma_f32_16x16x32_bf16 v[192:195], v[112:115], a[172:175], v[192:195]
    buffer_store_dwordx2 v[206:207], v251, s[36:39], s76 offen offset:512 sc0 sc1
    v_mfma_f32_16x16x32_bf16 v[192:195], v[128:131], a[188:191], v[192:195]
    s_waitcnt lgkmcnt(0)
    v_mul_f32 v142, v142, v222
    v_mul_f32 v158, v158, v222
    v_mfma_f32_16x16x32_bf16 v[148:151], v[84:87], a[128:131], v[148:151]
    v_mul_f32 v174, v174, v222
    v_mul_f32 v190, v190, v222
    v_mfma_f32_16x16x32_bf16 v[148:151], v[100:103], a[144:147], v[148:151]
    v_cvt_pk_bf16_f32 v208, v142, v158
    v_cvt_pk_bf16_f32 v209, v174, v190
    v_mfma_f32_16x16x32_bf16 v[148:151], v[116:119], a[160:163], v[148:151]
    buffer_store_dwordx2 v[208:209], v251, s[36:39], s76 offen offset:1024 sc0 sc1
    v_mfma_f32_16x16x32_bf16 v[148:151], v[132:135], a[176:179], v[148:151]
    v_mul_f32 v143, v143, v223
    v_mul_f32 v159, v159, v223
    v_mfma_f32_16x16x32_bf16 v[164:167], v[84:87], a[132:135], v[164:167]
    v_mul_f32 v175, v175, v223
    v_mul_f32 v191, v191, v223
    v_mfma_f32_16x16x32_bf16 v[164:167], v[100:103], a[148:151], v[164:167]
    v_cvt_pk_bf16_f32 v210, v143, v159
    v_cvt_pk_bf16_f32 v211, v175, v191
    v_mfma_f32_16x16x32_bf16 v[164:167], v[116:119], a[164:167], v[164:167]
    buffer_store_dwordx2 v[210:211], v251, s[36:39], s76 offen offset:1536 sc0 sc1
    v_mfma_f32_16x16x32_bf16 v[164:167], v[132:135], a[180:183], v[164:167]
    s_mov_b32 s76, 8192
    v_mul_f32 v144, v144, v224
    v_mul_f32 v160, v160, v224
    v_mfma_f32_16x16x32_bf16 v[180:183], v[84:87], a[136:139], v[180:183]
    v_mul_f32 v176, v176, v224
    v_mul_f32 v192, v192, v224
    v_mfma_f32_16x16x32_bf16 v[180:183], v[100:103], a[152:155], v[180:183]
    v_cvt_pk_bf16_f32 v212, v144, v160
    v_cvt_pk_bf16_f32 v213, v176, v192
    v_mfma_f32_16x16x32_bf16 v[180:183], v[116:119], a[168:171], v[180:183]
    buffer_store_dwordx2 v[212:213], v251, s[36:39], s76 offen offset:0 sc0 sc1
    v_mfma_f32_16x16x32_bf16 v[180:183], v[132:135], a[184:187], v[180:183]
    v_mul_f32 v145, v145, v225
    v_mul_f32 v161, v161, v225
    v_mfma_f32_16x16x32_bf16 v[196:199], v[84:87], a[140:143], v[196:199]
    v_mul_f32 v177, v177, v225
    v_mul_f32 v193, v193, v225
    v_mfma_f32_16x16x32_bf16 v[196:199], v[100:103], a[156:159], v[196:199]
    v_cvt_pk_bf16_f32 v214, v145, v161
    v_cvt_pk_bf16_f32 v215, v177, v193
    v_mfma_f32_16x16x32_bf16 v[196:199], v[116:119], a[172:175], v[196:199]
    buffer_store_dwordx2 v[214:215], v251, s[36:39], s76 offen offset:512 sc0 sc1
    v_mfma_f32_16x16x32_bf16 v[196:199], v[132:135], a[188:191], v[196:199]
    v_mul_f32 v146, v146, v226
    v_mul_f32 v162, v162, v226
    v_mfma_f32_16x16x32_bf16 v[152:155], v[88:91], a[192:195], v[152:155]
    v_mul_f32 v178, v178, v226
    v_mul_f32 v194, v194, v226
    v_mfma_f32_16x16x32_bf16 v[152:155], v[104:107], a[208:211], v[152:155]
    v_cvt_pk_bf16_f32 v216, v146, v162
    v_cvt_pk_bf16_f32 v217, v178, v194
    v_mfma_f32_16x16x32_bf16 v[152:155], v[120:123], a[224:227], v[152:155]
    buffer_store_dwordx2 v[216:217], v251, s[36:39], s76 offen offset:1024 sc0 sc1
    v_mfma_f32_16x16x32_bf16 v[152:155], v[136:139], a[240:243], v[152:155]
    v_mul_f32 v147, v147, v227
    v_mul_f32 v163, v163, v227
    v_mfma_f32_16x16x32_bf16 v[168:171], v[88:91], a[196:199], v[168:171]
    v_mul_f32 v179, v179, v227
    v_mul_f32 v195, v195, v227
    v_mfma_f32_16x16x32_bf16 v[168:171], v[104:107], a[212:215], v[168:171]
    v_cvt_pk_bf16_f32 v218, v147, v163
    v_cvt_pk_bf16_f32 v219, v179, v195
    v_mfma_f32_16x16x32_bf16 v[168:171], v[120:123], a[228:231], v[168:171]
    buffer_store_dwordx2 v[218:219], v251, s[36:39], s76 offen offset:1536 sc0 sc1
    v_mfma_f32_16x16x32_bf16 v[168:171], v[136:139], a[244:247], v[168:171]
    s_mov_b32 s76, 16384
    v_mul_f32 v148, v148, v228
    v_mul_f32 v164, v164, v228
    v_mfma_f32_16x16x32_bf16 v[184:187], v[88:91], a[200:203], v[184:187]
    v_mul_f32 v180, v180, v228
    v_mul_f32 v196, v196, v228
    v_mfma_f32_16x16x32_bf16 v[184:187], v[104:107], a[216:219], v[184:187]
    v_cvt_pk_bf16_f32 v204, v148, v164
    v_cvt_pk_bf16_f32 v205, v180, v196
    v_mfma_f32_16x16x32_bf16 v[184:187], v[120:123], a[232:235], v[184:187]
    buffer_store_dwordx2 v[204:205], v251, s[36:39], s76 offen offset:0 sc0 sc1
    v_mfma_f32_16x16x32_bf16 v[184:187], v[136:139], a[248:251], v[184:187]
    v_mul_f32 v149, v149, v229
    v_mul_f32 v165, v165, v229
    v_mfma_f32_16x16x32_bf16 v[200:203], v[88:91], a[204:207], v[200:203]
    v_mul_f32 v181, v181, v229
    v_mul_f32 v197, v197, v229
    v_mfma_f32_16x16x32_bf16 v[200:203], v[104:107], a[220:223], v[200:203]
    v_cvt_pk_bf16_f32 v206, v149, v165
    v_cvt_pk_bf16_f32 v207, v181, v197
    v_mfma_f32_16x16x32_bf16 v[200:203], v[120:123], a[236:239], v[200:203]
    buffer_store_dwordx2 v[206:207], v251, s[36:39], s76 offen offset:512 sc0 sc1
    v_mfma_f32_16x16x32_bf16 v[200:203], v[136:139], a[252:255], v[200:203]
    s_waitcnt lgkmcnt(0)
    v_mul_f32 v150, v150, v230
    v_mul_f32 v166, v166, v230
    v_mfma_f32_16x16x32_bf16 v[152:155], v[76:79], a[128:131], v[152:155]
    v_mul_f32 v182, v182, v230
    v_mul_f32 v198, v198, v230
    v_mfma_f32_16x16x32_bf16 v[152:155], v[92:95], a[144:147], v[152:155]
    v_cvt_pk_bf16_f32 v208, v150, v166
    v_cvt_pk_bf16_f32 v209, v182, v198
    v_mfma_f32_16x16x32_bf16 v[152:155], v[108:111], a[160:163], v[152:155]
    buffer_store_dwordx2 v[208:209], v251, s[36:39], s76 offen offset:1024 sc0 sc1
    v_mfma_f32_16x16x32_bf16 v[152:155], v[124:127], a[176:179], v[152:155]
    v_mul_f32 v151, v151, v231
    v_mul_f32 v167, v167, v231
    v_mfma_f32_16x16x32_bf16 v[168:171], v[76:79], a[132:135], v[168:171]
    v_mul_f32 v183, v183, v231
    v_mul_f32 v199, v199, v231
    v_mfma_f32_16x16x32_bf16 v[168:171], v[92:95], a[148:151], v[168:171]
    v_cvt_pk_bf16_f32 v210, v151, v167
    v_cvt_pk_bf16_f32 v211, v183, v199
    v_mfma_f32_16x16x32_bf16 v[168:171], v[108:111], a[164:167], v[168:171]
    buffer_store_dwordx2 v[210:211], v251, s[36:39], s76 offen offset:1536 sc0 sc1
    v_mfma_f32_16x16x32_bf16 v[168:171], v[124:127], a[180:183], v[168:171]
    s_mov_b32 s76, 24576
    v_mfma_f32_16x16x32_bf16 v[184:187], v[76:79], a[136:139], v[184:187]
    v_mfma_f32_16x16x32_bf16 v[184:187], v[92:95], a[152:155], v[184:187]
    v_mfma_f32_16x16x32_bf16 v[184:187], v[108:111], a[168:171], v[184:187]
    v_mfma_f32_16x16x32_bf16 v[184:187], v[124:127], a[184:187], v[184:187]
    v_mfma_f32_16x16x32_bf16 v[200:203], v[76:79], a[140:143], v[200:203]
    v_mfma_f32_16x16x32_bf16 v[200:203], v[92:95], a[156:159], v[200:203]
    v_mfma_f32_16x16x32_bf16 v[200:203], v[108:111], a[172:175], v[200:203]
    v_mfma_f32_16x16x32_bf16 v[200:203], v[124:127], a[188:191], v[200:203]
    s_nop 7
    v_mul_f32 v152, v152, v232
    v_mul_f32 v168, v168, v232
    v_mul_f32 v184, v184, v232
    v_mul_f32 v200, v200, v232
    v_cvt_pk_bf16_f32 v212, v152, v168
    v_cvt_pk_bf16_f32 v213, v184, v200
    buffer_store_dwordx2 v[212:213], v251, s[36:39], s76 offen offset:0 sc0 sc1
    v_mul_f32 v153, v153, v233
    v_mul_f32 v169, v169, v233
    v_mul_f32 v185, v185, v233
    v_mul_f32 v201, v201, v233
    v_cvt_pk_bf16_f32 v214, v153, v169
    v_cvt_pk_bf16_f32 v215, v185, v201
    buffer_store_dwordx2 v[214:215], v251, s[36:39], s76 offen offset:512 sc0 sc1
    v_mul_f32 v154, v154, v234
    v_mul_f32 v170, v170, v234
    v_mul_f32 v186, v186, v234
    v_mul_f32 v202, v202, v234
    v_cvt_pk_bf16_f32 v216, v154, v170
    v_cvt_pk_bf16_f32 v217, v186, v202
    buffer_store_dwordx2 v[216:217], v251, s[36:39], s76 offen offset:1024 sc0 sc1
    v_mul_f32 v155, v155, v235
    v_mul_f32 v171, v171, v235
    v_mul_f32 v187, v187, v235
    v_mul_f32 v203, v203, v235
    v_cvt_pk_bf16_f32 v218, v155, v171
    v_cvt_pk_bf16_f32 v219, v187, v203
    buffer_store_dwordx2 v[218:219], v251, s[36:39], s76 offen offset:1536 sc0 sc1
L_done:
    s_endpgm
L_table_rope:
    buffer_load_dwordx4 v[44:47], v246, s[40:43], s71 offen offset:0
    buffer_load_dwordx4 v[48:51], v246, s[40:43], s71 offen offset:256
    buffer_load_dwordx4 v[52:55], v246, s[44:47], 0 offen offset:0
    buffer_load_dwordx4 v[56:59], v246, s[48:51], 0 offen offset:0
    buffer_load_dwordx4 v[60:63], v246, s[44:47], 0 offen offset:256
    buffer_load_dwordx4 v[64:67], v246, s[48:51], 0 offen offset:256
    s_waitcnt vmcnt(0) lgkmcnt(0)
    v_lshlrev_b32 v12, 16, v44
    v_lshlrev_b32 v13, 16, v48
    v_lshlrev_b32 v14, 16, v52
    v_lshlrev_b32 v15, 16, v56
    v_lshlrev_b32 v16, 16, v60
    v_lshlrev_b32 v17, 16, v64
    v_mul_f32 v14, v14, v12
    v_mul_f32 v16, v16, v13
    v_fma_f32 v20, -v13, v15, v14
    v_fma_f32 v28, v12, v17, v16
    v_and_b32 v12, s72, v44
    v_and_b32 v13, s72, v48
    v_and_b32 v14, s72, v52
    v_and_b32 v15, s72, v56
    v_and_b32 v16, s72, v60
    v_and_b32 v17, s72, v64
    v_mul_f32 v14, v14, v12
    v_mul_f32 v16, v16, v13
    v_fma_f32 v21, -v13, v15, v14
    v_fma_f32 v29, v12, v17, v16
    v_lshlrev_b32 v12, 16, v45
    v_lshlrev_b32 v13, 16, v49
    v_lshlrev_b32 v14, 16, v53
    v_lshlrev_b32 v15, 16, v57
    v_lshlrev_b32 v16, 16, v61
    v_lshlrev_b32 v17, 16, v65
    v_mul_f32 v14, v14, v12
    v_mul_f32 v16, v16, v13
    v_fma_f32 v22, -v13, v15, v14
    v_fma_f32 v30, v12, v17, v16
    v_and_b32 v12, s72, v45
    v_and_b32 v13, s72, v49
    v_and_b32 v14, s72, v53
    v_and_b32 v15, s72, v57
    v_and_b32 v16, s72, v61
    v_and_b32 v17, s72, v65
    v_mul_f32 v14, v14, v12
    v_mul_f32 v16, v16, v13
    v_fma_f32 v23, -v13, v15, v14
    v_fma_f32 v31, v12, v17, v16
    v_lshlrev_b32 v12, 16, v46
    v_lshlrev_b32 v13, 16, v50
    v_lshlrev_b32 v14, 16, v54
    v_lshlrev_b32 v15, 16, v58
    v_lshlrev_b32 v16, 16, v62
    v_lshlrev_b32 v17, 16, v66
    v_mul_f32 v14, v14, v12
    v_mul_f32 v16, v16, v13
    v_fma_f32 v24, -v13, v15, v14
    v_fma_f32 v32, v12, v17, v16
    v_and_b32 v12, s72, v46
    v_and_b32 v13, s72, v50
    v_and_b32 v14, s72, v54
    v_and_b32 v15, s72, v58
    v_and_b32 v16, s72, v62
    v_and_b32 v17, s72, v66
    v_mul_f32 v14, v14, v12
    v_mul_f32 v16, v16, v13
    v_fma_f32 v25, -v13, v15, v14
    v_fma_f32 v33, v12, v17, v16
    v_lshlrev_b32 v12, 16, v47
    v_lshlrev_b32 v13, 16, v51
    v_lshlrev_b32 v14, 16, v55
    v_lshlrev_b32 v15, 16, v59
    v_lshlrev_b32 v16, 16, v63
    v_lshlrev_b32 v17, 16, v67
    v_mul_f32 v14, v14, v12
    v_mul_f32 v16, v16, v13
    v_fma_f32 v26, -v13, v15, v14
    v_fma_f32 v34, v12, v17, v16
    v_and_b32 v12, s72, v47
    v_and_b32 v13, s72, v51
    v_and_b32 v14, s72, v55
    v_and_b32 v15, s72, v59
    v_and_b32 v16, s72, v63
    v_and_b32 v17, s72, v67
    v_mul_f32 v14, v14, v12
    v_mul_f32 v16, v16, v13
    v_fma_f32 v27, -v13, v15, v14
    v_fma_f32 v35, v12, v17, v16
    v_cvt_pk_bf16_f32 v20, v20, v21
    v_cvt_pk_bf16_f32 v28, v28, v29
    v_cvt_pk_bf16_f32 v21, v22, v23
    v_cvt_pk_bf16_f32 v29, v30, v31
    v_cvt_pk_bf16_f32 v22, v24, v25
    v_cvt_pk_bf16_f32 v30, v32, v33
    v_cvt_pk_bf16_f32 v23, v26, v27
    v_cvt_pk_bf16_f32 v31, v34, v35
    ds_write_b128 v247, v[20:23] offset:32768
    ds_write_b128 v247, v[28:31] offset:36864
    buffer_load_dwordx4 v[44:47], v246, s[40:43], s71 offen offset:64
    buffer_load_dwordx4 v[48:51], v246, s[40:43], s71 offen offset:320
    buffer_load_dwordx4 v[52:55], v246, s[44:47], 0 offen offset:64
    buffer_load_dwordx4 v[56:59], v246, s[48:51], 0 offen offset:64
    buffer_load_dwordx4 v[60:63], v246, s[44:47], 0 offen offset:320
    buffer_load_dwordx4 v[64:67], v246, s[48:51], 0 offen offset:320
    s_waitcnt vmcnt(0) lgkmcnt(0)
    v_lshlrev_b32 v12, 16, v44
    v_lshlrev_b32 v13, 16, v48
    v_lshlrev_b32 v14, 16, v52
    v_lshlrev_b32 v15, 16, v56
    v_lshlrev_b32 v16, 16, v60
    v_lshlrev_b32 v17, 16, v64
    v_mul_f32 v14, v14, v12
    v_mul_f32 v16, v16, v13
    v_fma_f32 v20, -v13, v15, v14
    v_fma_f32 v28, v12, v17, v16
    v_and_b32 v12, s72, v44
    v_and_b32 v13, s72, v48
    v_and_b32 v14, s72, v52
    v_and_b32 v15, s72, v56
    v_and_b32 v16, s72, v60
    v_and_b32 v17, s72, v64
    v_mul_f32 v14, v14, v12
    v_mul_f32 v16, v16, v13
    v_fma_f32 v21, -v13, v15, v14
    v_fma_f32 v29, v12, v17, v16
    v_lshlrev_b32 v12, 16, v45
    v_lshlrev_b32 v13, 16, v49
    v_lshlrev_b32 v14, 16, v53
    v_lshlrev_b32 v15, 16, v57
    v_lshlrev_b32 v16, 16, v61
    v_lshlrev_b32 v17, 16, v65
    v_mul_f32 v14, v14, v12
    v_mul_f32 v16, v16, v13
    v_fma_f32 v22, -v13, v15, v14
    v_fma_f32 v30, v12, v17, v16
    v_and_b32 v12, s72, v45
    v_and_b32 v13, s72, v49
    v_and_b32 v14, s72, v53
    v_and_b32 v15, s72, v57
    v_and_b32 v16, s72, v61
    v_and_b32 v17, s72, v65
    v_mul_f32 v14, v14, v12
    v_mul_f32 v16, v16, v13
    v_fma_f32 v23, -v13, v15, v14
    v_fma_f32 v31, v12, v17, v16
    v_lshlrev_b32 v12, 16, v46
    v_lshlrev_b32 v13, 16, v50
    v_lshlrev_b32 v14, 16, v54
    v_lshlrev_b32 v15, 16, v58
    v_lshlrev_b32 v16, 16, v62
    v_lshlrev_b32 v17, 16, v66
    v_mul_f32 v14, v14, v12
    v_mul_f32 v16, v16, v13
    v_fma_f32 v24, -v13, v15, v14
    v_fma_f32 v32, v12, v17, v16
    v_and_b32 v12, s72, v46
    v_and_b32 v13, s72, v50
    v_and_b32 v14, s72, v54
    v_and_b32 v15, s72, v58
    v_and_b32 v16, s72, v62
    v_and_b32 v17, s72, v66
    v_mul_f32 v14, v14, v12
    v_mul_f32 v16, v16, v13
    v_fma_f32 v25, -v13, v15, v14
    v_fma_f32 v33, v12, v17, v16
    v_lshlrev_b32 v12, 16, v47
    v_lshlrev_b32 v13, 16, v51
    v_lshlrev_b32 v14, 16, v55
    v_lshlrev_b32 v15, 16, v59
    v_lshlrev_b32 v16, 16, v63
    v_lshlrev_b32 v17, 16, v67
    v_mul_f32 v14, v14, v12
    v_mul_f32 v16, v16, v13
    v_fma_f32 v26, -v13, v15, v14
    v_fma_f32 v34, v12, v17, v16
    v_and_b32 v12, s72, v47
    v_and_b32 v13, s72, v51
    v_and_b32 v14, s72, v55
    v_and_b32 v15, s72, v59
    v_and_b32 v16, s72, v63
    v_and_b32 v17, s72, v67
    v_mul_f32 v14, v14, v12
    v_mul_f32 v16, v16, v13
    v_fma_f32 v27, -v13, v15, v14
    v_fma_f32 v35, v12, v17, v16
    v_cvt_pk_bf16_f32 v20, v20, v21
    v_cvt_pk_bf16_f32 v28, v28, v29
    v_cvt_pk_bf16_f32 v21, v22, v23
    v_cvt_pk_bf16_f32 v29, v30, v31
    v_cvt_pk_bf16_f32 v22, v24, v25
    v_cvt_pk_bf16_f32 v30, v32, v33
    v_cvt_pk_bf16_f32 v23, v26, v27
    v_cvt_pk_bf16_f32 v31, v34, v35
    ds_write_b128 v247, v[20:23] offset:33792
    ds_write_b128 v247, v[28:31] offset:37888
    buffer_load_dwordx4 v[44:47], v246, s[40:43], s71 offen offset:128
    buffer_load_dwordx4 v[48:51], v246, s[40:43], s71 offen offset:384
    buffer_load_dwordx4 v[52:55], v246, s[44:47], 0 offen offset:128
    buffer_load_dwordx4 v[56:59], v246, s[48:51], 0 offen offset:128
    buffer_load_dwordx4 v[60:63], v246, s[44:47], 0 offen offset:384
    buffer_load_dwordx4 v[64:67], v246, s[48:51], 0 offen offset:384
    s_waitcnt vmcnt(0) lgkmcnt(0)
    v_lshlrev_b32 v12, 16, v44
    v_lshlrev_b32 v13, 16, v48
    v_lshlrev_b32 v14, 16, v52
    v_lshlrev_b32 v15, 16, v56
    v_lshlrev_b32 v16, 16, v60
    v_lshlrev_b32 v17, 16, v64
    v_mul_f32 v14, v14, v12
    v_mul_f32 v16, v16, v13
    v_fma_f32 v20, -v13, v15, v14
    v_fma_f32 v28, v12, v17, v16
    v_and_b32 v12, s72, v44
    v_and_b32 v13, s72, v48
    v_and_b32 v14, s72, v52
    v_and_b32 v15, s72, v56
    v_and_b32 v16, s72, v60
    v_and_b32 v17, s72, v64
    v_mul_f32 v14, v14, v12
    v_mul_f32 v16, v16, v13
    v_fma_f32 v21, -v13, v15, v14
    v_fma_f32 v29, v12, v17, v16
    v_lshlrev_b32 v12, 16, v45
    v_lshlrev_b32 v13, 16, v49
    v_lshlrev_b32 v14, 16, v53
    v_lshlrev_b32 v15, 16, v57
    v_lshlrev_b32 v16, 16, v61
    v_lshlrev_b32 v17, 16, v65
    v_mul_f32 v14, v14, v12
    v_mul_f32 v16, v16, v13
    v_fma_f32 v22, -v13, v15, v14
    v_fma_f32 v30, v12, v17, v16
    v_and_b32 v12, s72, v45
    v_and_b32 v13, s72, v49
    v_and_b32 v14, s72, v53
    v_and_b32 v15, s72, v57
    v_and_b32 v16, s72, v61
    v_and_b32 v17, s72, v65
    v_mul_f32 v14, v14, v12
    v_mul_f32 v16, v16, v13
    v_fma_f32 v23, -v13, v15, v14
    v_fma_f32 v31, v12, v17, v16
    v_lshlrev_b32 v12, 16, v46
    v_lshlrev_b32 v13, 16, v50
    v_lshlrev_b32 v14, 16, v54
    v_lshlrev_b32 v15, 16, v58
    v_lshlrev_b32 v16, 16, v62
    v_lshlrev_b32 v17, 16, v66
    v_mul_f32 v14, v14, v12
    v_mul_f32 v16, v16, v13
    v_fma_f32 v24, -v13, v15, v14
    v_fma_f32 v32, v12, v17, v16
    v_and_b32 v12, s72, v46
    v_and_b32 v13, s72, v50
    v_and_b32 v14, s72, v54
    v_and_b32 v15, s72, v58
    v_and_b32 v16, s72, v62
    v_and_b32 v17, s72, v66
    v_mul_f32 v14, v14, v12
    v_mul_f32 v16, v16, v13
    v_fma_f32 v25, -v13, v15, v14
    v_fma_f32 v33, v12, v17, v16
    v_lshlrev_b32 v12, 16, v47
    v_lshlrev_b32 v13, 16, v51
    v_lshlrev_b32 v14, 16, v55
    v_lshlrev_b32 v15, 16, v59
    v_lshlrev_b32 v16, 16, v63
    v_lshlrev_b32 v17, 16, v67
    v_mul_f32 v14, v14, v12
    v_mul_f32 v16, v16, v13
    v_fma_f32 v26, -v13, v15, v14
    v_fma_f32 v34, v12, v17, v16
    v_and_b32 v12, s72, v47
    v_and_b32 v13, s72, v51
    v_and_b32 v14, s72, v55
    v_and_b32 v15, s72, v59
    v_and_b32 v16, s72, v63
    v_and_b32 v17, s72, v67
    v_mul_f32 v14, v14, v12
    v_mul_f32 v16, v16, v13
    v_fma_f32 v27, -v13, v15, v14
    v_fma_f32 v35, v12, v17, v16
    v_cvt_pk_bf16_f32 v20, v20, v21
    v_cvt_pk_bf16_f32 v28, v28, v29
    v_cvt_pk_bf16_f32 v21, v22, v23
    v_cvt_pk_bf16_f32 v29, v30, v31
    v_cvt_pk_bf16_f32 v22, v24, v25
    v_cvt_pk_bf16_f32 v30, v32, v33
    v_cvt_pk_bf16_f32 v23, v26, v27
    v_cvt_pk_bf16_f32 v31, v34, v35
    ds_write_b128 v247, v[20:23] offset:34816
    ds_write_b128 v247, v[28:31] offset:38912
    buffer_load_dwordx4 v[44:47], v246, s[40:43], s71 offen offset:192
    buffer_load_dwordx4 v[48:51], v246, s[40:43], s71 offen offset:448
    buffer_load_dwordx4 v[52:55], v246, s[44:47], 0 offen offset:192
    buffer_load_dwordx4 v[56:59], v246, s[48:51], 0 offen offset:192
    buffer_load_dwordx4 v[60:63], v246, s[44:47], 0 offen offset:448
    buffer_load_dwordx4 v[64:67], v246, s[48:51], 0 offen offset:448
    s_waitcnt vmcnt(0) lgkmcnt(0)
    v_lshlrev_b32 v12, 16, v44
    v_lshlrev_b32 v13, 16, v48
    v_lshlrev_b32 v14, 16, v52
    v_lshlrev_b32 v15, 16, v56
    v_lshlrev_b32 v16, 16, v60
    v_lshlrev_b32 v17, 16, v64
    v_mul_f32 v14, v14, v12
    v_mul_f32 v16, v16, v13
    v_fma_f32 v20, -v13, v15, v14
    v_fma_f32 v28, v12, v17, v16
    v_and_b32 v12, s72, v44
    v_and_b32 v13, s72, v48
    v_and_b32 v14, s72, v52
    v_and_b32 v15, s72, v56
    v_and_b32 v16, s72, v60
    v_and_b32 v17, s72, v64
    v_mul_f32 v14, v14, v12
    v_mul_f32 v16, v16, v13
    v_fma_f32 v21, -v13, v15, v14
    v_fma_f32 v29, v12, v17, v16
    v_lshlrev_b32 v12, 16, v45
    v_lshlrev_b32 v13, 16, v49
    v_lshlrev_b32 v14, 16, v53
    v_lshlrev_b32 v15, 16, v57
    v_lshlrev_b32 v16, 16, v61
    v_lshlrev_b32 v17, 16, v65
    v_mul_f32 v14, v14, v12
    v_mul_f32 v16, v16, v13
    v_fma_f32 v22, -v13, v15, v14
    v_fma_f32 v30, v12, v17, v16
    v_and_b32 v12, s72, v45
    v_and_b32 v13, s72, v49
    v_and_b32 v14, s72, v53
    v_and_b32 v15, s72, v57
    v_and_b32 v16, s72, v61
    v_and_b32 v17, s72, v65
    v_mul_f32 v14, v14, v12
    v_mul_f32 v16, v16, v13
    v_fma_f32 v23, -v13, v15, v14
    v_fma_f32 v31, v12, v17, v16
    v_lshlrev_b32 v12, 16, v46
    v_lshlrev_b32 v13, 16, v50
    v_lshlrev_b32 v14, 16, v54
    v_lshlrev_b32 v15, 16, v58
    v_lshlrev_b32 v16, 16, v62
    v_lshlrev_b32 v17, 16, v66
    v_mul_f32 v14, v14, v12
    v_mul_f32 v16, v16, v13
    v_fma_f32 v24, -v13, v15, v14
    v_fma_f32 v32, v12, v17, v16
    v_and_b32 v12, s72, v46
    v_and_b32 v13, s72, v50
    v_and_b32 v14, s72, v54
    v_and_b32 v15, s72, v58
    v_and_b32 v16, s72, v62
    v_and_b32 v17, s72, v66
    v_mul_f32 v14, v14, v12
    v_mul_f32 v16, v16, v13
    v_fma_f32 v25, -v13, v15, v14
    v_fma_f32 v33, v12, v17, v16
    v_lshlrev_b32 v12, 16, v47
    v_lshlrev_b32 v13, 16, v51
    v_lshlrev_b32 v14, 16, v55
    v_lshlrev_b32 v15, 16, v59
    v_lshlrev_b32 v16, 16, v63
    v_lshlrev_b32 v17, 16, v67
    v_mul_f32 v14, v14, v12
    v_mul_f32 v16, v16, v13
    v_fma_f32 v26, -v13, v15, v14
    v_fma_f32 v34, v12, v17, v16
    v_and_b32 v12, s72, v47
    v_and_b32 v13, s72, v51
    v_and_b32 v14, s72, v55
    v_and_b32 v15, s72, v59
    v_and_b32 v16, s72, v63
    v_and_b32 v17, s72, v67
    v_mul_f32 v14, v14, v12
    v_mul_f32 v16, v16, v13
    v_fma_f32 v27, -v13, v15, v14
    v_fma_f32 v35, v12, v17, v16
    v_cvt_pk_bf16_f32 v20, v20, v21
    v_cvt_pk_bf16_f32 v28, v28, v29
    v_cvt_pk_bf16_f32 v21, v22, v23
    v_cvt_pk_bf16_f32 v29, v30, v31
    v_cvt_pk_bf16_f32 v22, v24, v25
    v_cvt_pk_bf16_f32 v30, v32, v33
    v_cvt_pk_bf16_f32 v23, v26, v27
    v_cvt_pk_bf16_f32 v31, v34, v35
    ds_write_b128 v247, v[20:23] offset:35840
    ds_write_b128 v247, v[28:31] offset:39936
    s_branch L_table_back
L_pw0:
    s_mov_b32 s87, 0x400000
L_pw0_l:
    ds_read_b32 v241, v243
    s_sub_u32 s87, s87, 1
    s_cbranch_scc1 L_pw0_back
    s_waitcnt lgkmcnt(0)
    v_add_u32 v241, 1, v241
    v_cmp_gt_u32 vcc, v240, v241
    s_nop 4
    s_cbranch_vccnz L_pw0_l
    s_branch L_pw0_back
L_pw1:
    s_mov_b32 s87, 0x400000
L_pw1_l:
    ds_read_b32 v241, v243
    s_sub_u32 s87, s87, 1
    s_cbranch_scc1 L_pw1_back
    s_waitcnt lgkmcnt(0)
    v_add_u32 v241, 1, v241
    v_cmp_gt_u32 vcc, v240, v241
    s_nop 4
    s_cbranch_vccnz L_pw1_l
    s_branch L_pw1_back
L_pw14:
    s_mov_b32 s87, 0x400000
L_pw14_l:
    ds_read_b32 v241, v243
    s_sub_u32 s87, s87, 1
    s_cbranch_scc1 L_pw14_back
    s_waitcnt lgkmcnt(0)
    v_add_u32 v241, 1, v241
    v_cmp_gt_u32 vcc, v240, v241
    s_nop 4
    s_cbranch_vccnz L_pw14_l
    s_branch L_pw14_back
L_event:
    s_cmp_eq_u32 s68, 6
    s_cbranch_scc1 L_ev_poll
    s_cmp_eq_u32 s68, 5
    s_cbranch_scc1 L_ev_check
    s_branch L_event_back
L_ev_poll:
    buffer_load_dwordx4 v[232:235], v1, s[32:35], 0 offen offset:2048 sc1
    buffer_load_dwordx4 v[236:239], v1, s[32:35], 0 offen offset:3072 sc1
    s_branch L_event_back
L_ev_check:
    s_waitcnt vmcnt(32)
    v_xor_b32 v232, s77, v232
    v_xor_b32 v233, s3, v233
    v_xor_b32 v234, s77, v234
    v_xor_b32 v235, s3, v235
    v_xor_b32 v236, s77, v236
    v_xor_b32 v237, s3, v237
    v_xor_b32 v238, s77, v238
    v_xor_b32 v239, s3, v239
    v_or3_b32 v232, v232, v233, v234
    v_or3_b32 v235, v235, v236, v237
    v_or3_b32 v232, v232, v238, v239
    v_or_b32 v232, v232, v235
    v_cmp_eq_u32 vcc, 0, v232
    s_nop 3
    s_cmp_eq_u64 vcc, -1
    s_cbranch_scc1 L_check_back
L_spin1:
    s_mov_b32 s87, 0x400000
L_spin1_l:
    buffer_load_dwordx4 v[232:235], v1, s[32:35], 0 offen offset:2048 sc1
    buffer_load_dwordx4 v[236:239], v1, s[32:35], 0 offen offset:3072 sc1
    s_waitcnt vmcnt(0)
    v_xor_b32 v232, s77, v232
    v_xor_b32 v233, s3, v233
    v_xor_b32 v234, s77, v234
    v_xor_b32 v235, s3, v235
    v_xor_b32 v236, s77, v236
    v_xor_b32 v237, s3, v237
    v_xor_b32 v238, s77, v238
    v_xor_b32 v239, s3, v239
    v_or3_b32 v232, v232, v233, v234
    v_or3_b32 v235, v235, v236, v237
    v_or3_b32 v232, v232, v238, v239
    v_or_b32 v232, v232, v235
    v_cmp_eq_u32 vcc, 0, v232
    s_nop 3
    s_cmp_eq_u64 vcc, -1
    s_cbranch_scc1 L_check_back
    s_sub_u32 s87, s87, 1
    s_cbranch_scc1 L_check_back
    s_sleep 1
    s_branch L_spin1_l
L_spin0:
    s_mov_b32 s87, 0x400000
L_spin0_l:
    buffer_load_dwordx4 v[232:235], v1, s[32:35], 0 offen offset:0 sc1
    buffer_load_dwordx4 v[236:239], v1, s[32:35], 0 offen offset:1024 sc1
    s_waitcnt vmcnt(0)
    v_xor_b32 v232, s77, v232
    v_xor_b32 v233, s3, v233
    v_xor_b32 v234, s77, v234
    v_xor_b32 v235, s3, v235
    v_xor_b32 v236, s77, v236
    v_xor_b32 v237, s3, v237
    v_xor_b32 v238, s77, v238
    v_xor_b32 v239, s3, v239
    v_or3_b32 v232, v232, v233, v234
    v_or3_b32 v235, v235, v236, v237
    v_or3_b32 v232, v232, v238, v239
    v_or_b32 v232, v232, v235
    v_cmp_eq_u32 vcc, 0, v232
    s_nop 3
    s_cmp_eq_u64 vcc, -1
    s_cbranch_scc1 L_spin0_back
    s_sub_u32 s87, s87, 1
    s_cbranch_scc1 L_spin0_back
    s_sleep 1
    s_branch L_spin0_l
L_tag_spin:
    s_mov_b32 s87, 0x400000
L_tag_spin_l:
    buffer_load_dwordx2 v[234:235], v249, s[52:55], 0 offen sc1
    s_waitcnt vmcnt(0)
    v_readfirstlane_b32 s77, v234
    v_readfirstlane_b32 s3, v235
    s_sub_u32 s87, s87, 1
    s_cbranch_scc1 L_tag_ok
    s_sleep 1
    s_cmp_eq_u32 s77, 0
    s_cbranch_scc1 L_tag_spin_l
    s_cmp_eq_u32 s3, 0
    s_cbranch_scc1 L_tag_spin_l
    s_branch L_tag_ok
L_fallback:
    s_mov_b32 s71, 1
    s_mov_b32 s86, 64
    s_waitcnt lgkmcnt(0)
    s_waitcnt vmcnt(0)
    v_mov_b32 v204, 0xff800000
    v_mov_b32 v205, 0xff800000
    v_mov_b32 v206, 0xff800000
    v_mov_b32 v207, 0xff800000
    s_mov_b32 s69, 0
    s_mov_b32 s68, 16
L_fb_loop:
    buffer_load_dwordx4 a[128:131], off, s[8:11], s69 offset:0 sc1
    buffer_load_dwordx4 a[132:135], off, s[8:11], s69 offset:1024 sc1
    buffer_load_dwordx4 a[136:139], off, s[8:11], s69 offset:2048 sc1
    buffer_load_dwordx4 a[140:143], off, s[8:11], s69 offset:3072 sc1
    buffer_load_dwordx4 a[144:147], off, s[12:15], s69 offset:0 sc1
    buffer_load_dwordx4 a[148:151], off, s[12:15], s69 offset:1024 sc1
    buffer_load_dwordx4 a[152:155], off, s[12:15], s69 offset:2048 sc1
    buffer_load_dwordx4 a[156:159], off, s[12:15], s69 offset:3072 sc1
    buffer_load_dwordx4 a[160:163], off, s[16:19], s69 offset:0 sc1
    buffer_load_dwordx4 a[164:167], off, s[16:19], s69 offset:1024 sc1
    buffer_load_dwordx4 a[168:171], off, s[16:19], s69 offset:2048 sc1
    buffer_load_dwordx4 a[172:175], off, s[16:19], s69 offset:3072 sc1
    buffer_load_dwordx4 a[176:179], off, s[20:23], s69 offset:0 sc1
    buffer_load_dwordx4 a[180:183], off, s[20:23], s69 offset:1024 sc1
    buffer_load_dwordx4 a[184:187], off, s[20:23], s69 offset:2048 sc1
    buffer_load_dwordx4 a[188:191], off, s[20:23], s69 offset:3072 sc1
    s_waitcnt vmcnt(0)
    v_mfma_f32_16x16x32_bf16 v[44:47], a[128:131], a[0:3], 0
    v_mfma_f32_16x16x32_bf16 v[48:51], a[128:131], a[32:35], 0
    v_mfma_f32_16x16x32_bf16 v[52:55], a[128:131], a[64:67], 0
    v_mfma_f32_16x16x32_bf16 v[56:59], a[128:131], a[96:99], 0
    v_mfma_f32_16x16x32_bf16 v[44:47], a[132:135], a[4:7], v[44:47]
    v_mfma_f32_16x16x32_bf16 v[48:51], a[132:135], a[36:39], v[48:51]
    v_mfma_f32_16x16x32_bf16 v[52:55], a[132:135], a[68:71], v[52:55]
    v_mfma_f32_16x16x32_bf16 v[56:59], a[132:135], a[100:103], v[56:59]
    v_mfma_f32_16x16x32_bf16 v[44:47], a[136:139], a[8:11], v[44:47]
    v_mfma_f32_16x16x32_bf16 v[48:51], a[136:139], a[40:43], v[48:51]
    v_mfma_f32_16x16x32_bf16 v[52:55], a[136:139], a[72:75], v[52:55]
    v_mfma_f32_16x16x32_bf16 v[56:59], a[136:139], a[104:107], v[56:59]
    v_mfma_f32_16x16x32_bf16 v[44:47], a[140:143], a[12:15], v[44:47]
    v_mfma_f32_16x16x32_bf16 v[48:51], a[140:143], a[44:47], v[48:51]
    v_mfma_f32_16x16x32_bf16 v[52:55], a[140:143], a[76:79], v[52:55]
    v_mfma_f32_16x16x32_bf16 v[56:59], a[140:143], a[108:111], v[56:59]
    v_mfma_f32_16x16x32_bf16 v[44:47], a[144:147], a[16:19], v[44:47]
    v_mfma_f32_16x16x32_bf16 v[48:51], a[144:147], a[48:51], v[48:51]
    v_mfma_f32_16x16x32_bf16 v[52:55], a[144:147], a[80:83], v[52:55]
    v_mfma_f32_16x16x32_bf16 v[56:59], a[144:147], a[112:115], v[56:59]
    v_mfma_f32_16x16x32_bf16 v[44:47], a[148:151], a[20:23], v[44:47]
    v_mfma_f32_16x16x32_bf16 v[48:51], a[148:151], a[52:55], v[48:51]
    v_mfma_f32_16x16x32_bf16 v[52:55], a[148:151], a[84:87], v[52:55]
    v_mfma_f32_16x16x32_bf16 v[56:59], a[148:151], a[116:119], v[56:59]
    v_mfma_f32_16x16x32_bf16 v[44:47], a[152:155], a[24:27], v[44:47]
    v_mfma_f32_16x16x32_bf16 v[48:51], a[152:155], a[56:59], v[48:51]
    v_mfma_f32_16x16x32_bf16 v[52:55], a[152:155], a[88:91], v[52:55]
    v_mfma_f32_16x16x32_bf16 v[56:59], a[152:155], a[120:123], v[56:59]
    v_mfma_f32_16x16x32_bf16 v[44:47], a[156:159], a[28:31], v[44:47]
    v_mfma_f32_16x16x32_bf16 v[48:51], a[156:159], a[60:63], v[48:51]
    v_mfma_f32_16x16x32_bf16 v[52:55], a[156:159], a[92:95], v[52:55]
    v_mfma_f32_16x16x32_bf16 v[56:59], a[156:159], a[124:127], v[56:59]
    v_mfma_f32_16x16x32_bf16 v[60:63], a[160:163], a[0:3], 0
    v_mfma_f32_16x16x32_bf16 v[64:67], a[160:163], a[32:35], 0
    v_mfma_f32_16x16x32_bf16 v[68:71], a[160:163], a[64:67], 0
    v_mfma_f32_16x16x32_bf16 v[72:75], a[160:163], a[96:99], 0
    v_mfma_f32_16x16x32_bf16 v[60:63], a[164:167], a[4:7], v[60:63]
    v_mfma_f32_16x16x32_bf16 v[64:67], a[164:167], a[36:39], v[64:67]
    v_mfma_f32_16x16x32_bf16 v[68:71], a[164:167], a[68:71], v[68:71]
    v_mfma_f32_16x16x32_bf16 v[72:75], a[164:167], a[100:103], v[72:75]
    v_mfma_f32_16x16x32_bf16 v[60:63], a[168:171], a[8:11], v[60:63]
    v_mfma_f32_16x16x32_bf16 v[64:67], a[168:171], a[40:43], v[64:67]
    v_mfma_f32_16x16x32_bf16 v[68:71], a[168:171], a[72:75], v[68:71]
    v_mfma_f32_16x16x32_bf16 v[72:75], a[168:171], a[104:107], v[72:75]
    v_mfma_f32_16x16x32_bf16 v[60:63], a[172:175], a[12:15], v[60:63]
    v_mfma_f32_16x16x32_bf16 v[64:67], a[172:175], a[44:47], v[64:67]
    v_mfma_f32_16x16x32_bf16 v[68:71], a[172:175], a[76:79], v[68:71]
    v_mfma_f32_16x16x32_bf16 v[72:75], a[172:175], a[108:111], v[72:75]
    v_mfma_f32_16x16x32_bf16 v[60:63], a[176:179], a[16:19], v[60:63]
    v_mfma_f32_16x16x32_bf16 v[64:67], a[176:179], a[48:51], v[64:67]
    v_mfma_f32_16x16x32_bf16 v[68:71], a[176:179], a[80:83], v[68:71]
    v_mfma_f32_16x16x32_bf16 v[72:75], a[176:179], a[112:115], v[72:75]
    v_mfma_f32_16x16x32_bf16 v[60:63], a[180:183], a[20:23], v[60:63]
    v_mfma_f32_16x16x32_bf16 v[64:67], a[180:183], a[52:55], v[64:67]
    v_mfma_f32_16x16x32_bf16 v[68:71], a[180:183], a[84:87], v[68:71]
    v_mfma_f32_16x16x32_bf16 v[72:75], a[180:183], a[116:119], v[72:75]
    v_mfma_f32_16x16x32_bf16 v[60:63], a[184:187], a[24:27], v[60:63]
    v_mfma_f32_16x16x32_bf16 v[64:67], a[184:187], a[56:59], v[64:67]
    v_mfma_f32_16x16x32_bf16 v[68:71], a[184:187], a[88:91], v[68:71]
    v_mfma_f32_16x16x32_bf16 v[72:75], a[184:187], a[120:123], v[72:75]
    v_mfma_f32_16x16x32_bf16 v[60:63], a[188:191], a[28:31], v[60:63]
    v_mfma_f32_16x16x32_bf16 v[64:67], a[188:191], a[60:63], v[64:67]
    v_mfma_f32_16x16x32_bf16 v[68:71], a[188:191], a[92:95], v[68:71]
    v_mfma_f32_16x16x32_bf16 v[72:75], a[188:191], a[124:127], v[72:75]
    s_nop 15
    v_max3_f32 v204, v204, v44, v45
    v_max3_f32 v204, v204, v46, v47
    v_max3_f32 v204, v204, v60, v61
    v_max3_f32 v204, v204, v62, v63
    v_max3_f32 v205, v205, v48, v49
    v_max3_f32 v205, v205, v50, v51
    v_max3_f32 v205, v205, v64, v65
    v_max3_f32 v205, v205, v66, v67
    v_max3_f32 v206, v206, v52, v53
    v_max3_f32 v206, v206, v54, v55
    v_max3_f32 v206, v206, v68, v69
    v_max3_f32 v206, v206, v70, v71
    v_max3_f32 v207, v207, v56, v57
    v_max3_f32 v207, v207, v58, v59
    v_max3_f32 v207, v207, v72, v73
    v_max3_f32 v207, v207, v74, v75
    s_add_u32 s69, s69, 0x20000
    s_sub_u32 s68, s68, 1
    s_cmp_lg_u32 s68, 0
    s_cbranch_scc1 L_fb_loop
    v_lshrrev_b32 v213, 4, v0
    v_lshlrev_b32 v212, 2, v246
    s_lshl_b32 s76, s100, 4
    v_lshl_add_u32 v213, v213, 2, s76
    v_add_u32 v213, v213, v212
    ds_write_b32 v213, v204 offset:36864
    ds_write_b32 v213, v205 offset:37888
    ds_write_b32 v213, v206 offset:38912
    ds_write_b32 v213, v207 offset:39936
    s_waitcnt lgkmcnt(0)
    s_barrier
    ds_read_b128 v[76:79], v212 offset:36864
    ds_read_b128 v[80:83], v212 offset:36880
    ds_read_b128 v[84:87], v212 offset:36896
    ds_read_b128 v[88:91], v212 offset:36912
    s_waitcnt lgkmcnt(0)
    v_max3_f32 v204, v76, v77, v78
    v_max3_f32 v204, v204, v79, v80
    v_max3_f32 v204, v204, v81, v82
    v_max3_f32 v204, v204, v83, v84
    v_max3_f32 v204, v204, v85, v86
    v_max3_f32 v204, v204, v87, v88
    v_max3_f32 v204, v204, v89, v90
    v_max_f32 v204, v204, v91
    v_sub_f32 v12, 0, v204
    v_sub_f32 v13, 0, v204
    v_sub_f32 v14, 0, v204
    v_sub_f32 v15, 0, v204
    ds_read_b128 v[76:79], v212 offset:37888
    ds_read_b128 v[80:83], v212 offset:37904
    ds_read_b128 v[84:87], v212 offset:37920
    ds_read_b128 v[88:91], v212 offset:37936
    s_waitcnt lgkmcnt(0)
    v_max3_f32 v204, v76, v77, v78
    v_max3_f32 v204, v204, v79, v80
    v_max3_f32 v204, v204, v81, v82
    v_max3_f32 v204, v204, v83, v84
    v_max3_f32 v204, v204, v85, v86
    v_max3_f32 v204, v204, v87, v88
    v_max3_f32 v204, v204, v89, v90
    v_max_f32 v204, v204, v91
    v_sub_f32 v16, 0, v204
    v_sub_f32 v17, 0, v204
    v_sub_f32 v18, 0, v204
    v_sub_f32 v19, 0, v204
    ds_read_b128 v[76:79], v212 offset:38912
    ds_read_b128 v[80:83], v212 offset:38928
    ds_read_b128 v[84:87], v212 offset:38944
    ds_read_b128 v[88:91], v212 offset:38960
    s_waitcnt lgkmcnt(0)
    v_max3_f32 v204, v76, v77, v78
    v_max3_f32 v204, v204, v79, v80
    v_max3_f32 v204, v204, v81, v82
    v_max3_f32 v204, v204, v83, v84
    v_max3_f32 v204, v204, v85, v86
    v_max3_f32 v204, v204, v87, v88
    v_max3_f32 v204, v204, v89, v90
    v_max_f32 v204, v204, v91
    v_sub_f32 v20, 0, v204
    v_sub_f32 v21, 0, v204
    v_sub_f32 v22, 0, v204
    v_sub_f32 v23, 0, v204
    ds_read_b128 v[76:79], v212 offset:39936
    ds_read_b128 v[80:83], v212 offset:39952
    ds_read_b128 v[84:87], v212 offset:39968
    ds_read_b128 v[88:91], v212 offset:39984
    s_waitcnt lgkmcnt(0)
    v_max3_f32 v204, v76, v77, v78
    v_max3_f32 v204, v204, v79, v80
    v_max3_f32 v204, v204, v81, v82
    v_max3_f32 v204, v204, v83, v84
    v_max3_f32 v204, v204, v85, v86
    v_max3_f32 v204, v204, v87, v88
    v_max3_f32 v204, v204, v89, v90
    v_max_f32 v204, v204, v91
    v_sub_f32 v24, 0, v204
    v_sub_f32 v25, 0, v204
    v_sub_f32 v26, 0, v204
    v_sub_f32 v27, 0, v204
    v_mov_b32 v28, 0
    v_mov_b32 v29, 0
    v_mov_b32 v30, 0
    v_mov_b32 v31, 0
    v_mov_b32 v32, 0
    v_mov_b32 v33, 0
    v_mov_b32 v34, 0
    v_mov_b32 v35, 0
    v_mov_b32 v36, 0
    v_mov_b32 v37, 0
    v_mov_b32 v38, 0
    v_mov_b32 v39, 0
    v_mov_b32 v40, 0
    v_mov_b32 v41, 0
    v_mov_b32 v42, 0
    v_mov_b32 v43, 0
    v_mov_b32 v140, 0
    v_mov_b32 v141, 0
    v_mov_b32 v142, 0
    v_mov_b32 v143, 0
    v_mov_b32 v144, 0
    v_mov_b32 v145, 0
    v_mov_b32 v146, 0
    v_mov_b32 v147, 0
    v_mov_b32 v148, 0
    v_mov_b32 v149, 0
    v_mov_b32 v150, 0
    v_mov_b32 v151, 0
    v_mov_b32 v152, 0
    v_mov_b32 v153, 0
    v_mov_b32 v154, 0
    v_mov_b32 v155, 0
    v_mov_b32 v156, 0
    v_mov_b32 v157, 0
    v_mov_b32 v158, 0
    v_mov_b32 v159, 0
    v_mov_b32 v160, 0
    v_mov_b32 v161, 0
    v_mov_b32 v162, 0
    v_mov_b32 v163, 0
    v_mov_b32 v164, 0
    v_mov_b32 v165, 0
    v_mov_b32 v166, 0
    v_mov_b32 v167, 0
    v_mov_b32 v168, 0
    v_mov_b32 v169, 0
    v_mov_b32 v170, 0
    v_mov_b32 v171, 0
    v_mov_b32 v172, 0
    v_mov_b32 v173, 0
    v_mov_b32 v174, 0
    v_mov_b32 v175, 0
    v_mov_b32 v176, 0
    v_mov_b32 v177, 0
    v_mov_b32 v178, 0
    v_mov_b32 v179, 0
    v_mov_b32 v180, 0
    v_mov_b32 v181, 0
    v_mov_b32 v182, 0
    v_mov_b32 v183, 0
    v_mov_b32 v184, 0
    v_mov_b32 v185, 0
    v_mov_b32 v186, 0
    v_mov_b32 v187, 0
    v_mov_b32 v188, 0
    v_mov_b32 v189, 0
    v_mov_b32 v190, 0
    v_mov_b32 v191, 0
    v_mov_b32 v192, 0
    v_mov_b32 v193, 0
    v_mov_b32 v194, 0
    v_mov_b32 v195, 0
    v_mov_b32 v196, 0
    v_mov_b32 v197, 0
    v_mov_b32 v198, 0
    v_mov_b32 v199, 0
    v_mov_b32 v200, 0
    v_mov_b32 v201, 0
    v_mov_b32 v202, 0
    v_mov_b32 v203, 0
    s_mov_b64 s[92:93], s[84:85]
    s_and_b32 s69, s92, 15
    s_lshl_b32 s69, s69, 17
    s_mov_b64 s[96:97], s[84:85]
    s_and_b32 s70, s96, 15
    s_lshl_b32 s70, s70, 17
    s_or_b32 s70, s70, 0x4000
    buffer_load_dwordx4 a[128:131], off, s[8:11], s69 offset:0 sc1
    buffer_load_dwordx4 a[132:135], off, s[8:11], s69 offset:1024 sc1
    buffer_load_dwordx4 a[136:139], off, s[8:11], s69 offset:2048 sc1
    buffer_load_dwordx4 a[140:143], off, s[8:11], s69 offset:3072 sc1
    buffer_load_dwordx4 a[144:147], off, s[12:15], s69 offset:0 sc1
    buffer_load_dwordx4 a[148:151], off, s[12:15], s69 offset:1024 sc1
    buffer_load_dwordx4 a[152:155], off, s[12:15], s69 offset:2048 sc1
    buffer_load_dwordx4 a[156:159], off, s[12:15], s69 offset:3072 sc1
    buffer_load_dwordx4 a[160:163], off, s[16:19], s69 offset:0 sc1
    buffer_load_dwordx4 a[164:167], off, s[16:19], s69 offset:1024 sc1
    buffer_load_dwordx4 a[168:171], off, s[16:19], s69 offset:2048 sc1
    buffer_load_dwordx4 a[172:175], off, s[16:19], s69 offset:3072 sc1
    buffer_load_dwordx4 a[176:179], off, s[20:23], s69 offset:0 sc1
    buffer_load_dwordx4 a[180:183], off, s[20:23], s69 offset:1024 sc1
    buffer_load_dwordx4 a[184:187], off, s[20:23], s69 offset:2048 sc1
    buffer_load_dwordx4 a[188:191], off, s[20:23], s69 offset:3072 sc1
    buffer_load_dword v204, v1, s[4:7], 0 offen
    buffer_load_dword v204, v1, s[4:7], 0 offen
    buffer_load_dword v204, v1, s[4:7], 0 offen
    buffer_load_dword v204, v1, s[4:7], 0 offen
    buffer_load_dword v204, v1, s[4:7], 0 offen
    buffer_load_dword v204, v1, s[4:7], 0 offen
    s_lshr_b64 s[92:93], s[92:93], 4
    s_and_b32 s69, s92, 15
    s_lshl_b32 s69, s69, 17
    s_branch L_main
L_code_end:
.section .rodata,"a"
.p2align 6
.amdhsa_kernel standalone__kv_cache_quant_pre_rope_vs_post_rope__prompt_kernel
  .amdhsa_next_free_vgpr 512
  .amdhsa_next_free_sgpr 102
  .amdhsa_accum_offset 256
  .amdhsa_group_segment_fixed_size 0
  .amdhsa_kernarg_size 112
  .amdhsa_user_sgpr_count 2
  .amdhsa_user_sgpr_kernarg_segment_ptr 1
  .amdhsa_system_sgpr_workgroup_id_x 1
  .amdhsa_float_denorm_mode_32 3
.end_amdhsa_kernel
```
